```python
import torch

def _softmax(x, axis=-1):
    return torch.softmax(x, dim=axis)
def _gelu(x):
    return torch.nn.functional.gelu(x, approximate="tanh")
def _silu(x):
    return torch.nn.functional.silu(x)
def _sigmoid(x):
    return torch.sigmoid(x)
def _layernorm(x, axis=-1, eps=1e-5):
    m = x.mean(dim=axis, keepdim=True)
    v = x.var(dim=axis, keepdim=True, unbiased=False)
    return (x - m) / torch.sqrt(v + eps)
def _scatter_add(tgt, idx, src, axis=0):
    return tgt.clone().index_add_(axis, idx, src)
def _segment_sum(src, seg, n):
    out = torch.zeros((n,) + src.shape[1:], dtype=src.dtype)
    return out.index_add_(0, seg, src)
def _pad(x, pw):
    flat = tuple(v for pair in reversed(pw) for v in pair)
    return torch.nn.functional.pad(x, flat)

kernel_name = 'parallel_sum__compressed_kv_cla__dense_activation_squared_relu__decode'

def setup_inputs():

    _w = (lambda a: (lambda t: t.to(torch.bfloat16) if t.is_floating_point() else t)(torch.as_tensor(a)))
    def _A_setup():
        B, H, Sq, Sk, D, M = 2, 32, 1, 4096, 128, 576
        Dc = 4 * D
        return {
            "x": _w((lambda *s: torch.randn(*s, dtype=torch.bfloat16) * 0.05)(B, Sq, M)),
            "c_kv": _w((lambda *s: torch.randn(*s, dtype=torch.bfloat16) * 3.2)(B, Sk, Dc)),
            "w_q": _w((lambda *s: torch.randn(*s, dtype=torch.bfloat16) * 1.6)(M, H, D) * (M ** -0.5)),
            "w_uk": _w((lambda *s: torch.randn(*s, dtype=torch.bfloat16) * 1.6)(Dc, H, D) * (Dc ** -0.5)),
            "w_uv": _w((lambda *s: torch.randn(*s, dtype=torch.bfloat16) * 3.2)(Dc, H, D) * (Dc ** -0.5)),
            "w_o": _w((lambda *s: torch.randn(*s, dtype=torch.bfloat16) * 3.2)(H, D, M) * ((H * D) ** -0.5)),
        }
    _A_in = _A_setup()

    def _B_setup():
        B, S, D, F = 2, 1, 576, 4608
        return {
            "x": _w((lambda *s: torch.randn(*s, dtype=torch.bfloat16) * 0.05)(B, S, D)),
            "w1": _w((lambda *s: torch.randn(*s, dtype=torch.bfloat16) * 0.1)(D, F)),
            "b1": _w((lambda *s: torch.randn(*s, dtype=torch.bfloat16) * 0.4)(F)),
            "w2": _w((lambda *s: torch.randn(*s, dtype=torch.bfloat16) * 0.1)(F, D)),
            "b2": _w((lambda *s: torch.randn(*s, dtype=torch.bfloat16) * 12.8)(D)),
        }
    _B_in = _B_setup()

    return {
        "A_x": _A_in["x"],
        "A_c_kv": _A_in["c_kv"],
        "A_w_q": _A_in["w_q"],
        "A_w_uk": _A_in["w_uk"],
        "A_w_uv": _A_in["w_uv"],
        "A_w_o": _A_in["w_o"],
        "B_x": _B_in["x"],
        "B_w1": _B_in["w1"],
        "B_b1": _B_in["b1"],
        "B_w2": _B_in["w2"],
        "B_b2": _B_in["b2"],
    }

def reference(A_x, A_c_kv, A_w_q, A_w_uk, A_w_uv, A_w_o, B_x, B_w1, B_b1, B_w2, B_b2):
    def _A_ref(x, c_kv, w_q, w_uk, w_uv, w_o):
        B, Sq, M = x.shape[0], x.shape[1], x.shape[2]
        Sk = c_kv.shape[1]
        H, D = w_q.shape[1], w_q.shape[2]
        q = torch.einsum("bqm,mhd->bhqd", x, w_q)
        k = torch.einsum("bkc,chd->bhkd", c_kv, w_uk)
        v = torch.einsum("bkc,chd->bhkd", c_kv, w_uv)
        scores = torch.einsum("bhqd,bhkd->bhqk", q, k) * (D ** -0.5)
        off = Sk - Sq
        qi = torch.arange(Sq)[:, None]
        kj = torch.arange(Sk)[None, :]
        cmask = kj <= (qi + off)
        scores = torch.where(cmask[None, None], scores, -1e9)
        p = _softmax(scores, axis=-1)
        ctx = torch.einsum("bhqk,bhkd->bhqd", p, v)
        return torch.einsum("bhqd,hdm->bqm", ctx, w_o)

    def _B_ref(x, w1, b1, w2, b2):
        h = torch.einsum("bsd,df->bsf", x, w1) + b1
        zero = torch.zeros_like(h)
        r = torch.where(h > zero, h, zero)
        h = r * r
        out = torch.einsum("bsf,fd->bsd", h, w2) + b2
        return out

    x = A_x
    xn = _layernorm(x, axis=-1)
    return x + _A_ref(xn, A_c_kv, A_w_q, A_w_uk, A_w_uv, A_w_o) + _B_ref(xn, B_w1, B_b1, B_w2, B_b2)
```

```asm
; @launch grid=(256,1,1) block=(576,1,1) lds=156928
.amdgcn_target "amdgcn-amd-amdhsa--gfx950"
.text
.globl parallel_sum__compressed_kv_cla__dense_activation_squared_relu__decode_kernel
.p2align 12
.type parallel_sum__compressed_kv_cla__dense_activation_squared_relu__decode_kernel,@function
parallel_sum__compressed_kv_cla__dense_activation_squared_relu__decode_kernel:
    s_load_dwordx2 s[8:9], s[0:1], 16
    s_load_dwordx2 s[20:21], s[0:1], 24
    s_load_dwordx2 s[16:17], s[0:1], 0
    s_load_dwordx2 s[12:13], s[0:1], 104
    s_cmp_ge_u32 s2, 256
    s_cbranch_scc1 L_EXIT
    v_lshrrev_b32 v1, 6, v0
    v_and_b32 v0, 63, v0
    v_readfirstlane_b32 s3, v1
    v_lshlrev_b32 v1, 4, v0
    v_lshrrev_b32 v2, 4, v0
    v_and_b32 v3, 15, v0
    s_mov_b32 s11, 0x20000
    s_mov_b32 s10, 4718592
    s_mov_b32 s23, s11
    s_mov_b32 s22, 4194304
    s_mov_b32 s15, s11
    s_mov_b32 s14, 8388608
    s_cmp_ge_u32 s2, 128
    s_cbranch_scc1 L_Y
    s_mov_b32 s19, s11
    s_movk_i32 s18, 2304
    s_bfe_u32 s6, s2, 0x20003
    s_lshr_b32 s7, s2, 5
    s_add_u32 s45, s2, s7
    s_and_b32 s45, s45, 7
    s_lshl3_add_u32 s100, s7, s45
    v_lshlrev_b32 v8, 1, v2
    v_xor_b32 v8, v8, v3
    v_lshlrev_b32 v135, 4, v8
    v_lshl_add_u32 v4, v2, 13, v135
    s_mul_i32 s44, s6, 9
    s_add_u32 s44, s44, s3
    s_lshl_b32 s44, s44, 9
    s_add_u32 s44, s44, s100
    s_lshl_b32 s44, s44, 8
    s_mul_i32 m0, s3, 4608
    s_mov_b32 s47, 32768
    s_cmp_eq_u32 s3, 3
    s_cbranch_scc0 L_X_nox
    s_and_b32 s53, s2, 31
    s_mul_i32 s96, s53, 43
    s_lshr_b32 s96, s96, 7
    s_mul_i32 s97, s96, 3
    s_sub_u32 s97, s53, s97
    s_mul_i32 s45, s6, 288
    s_mul_i32 s7, s97, 384
    v_lshrrev_b32 v8, 5, v0
    v_mul_u32_u24 v8, 1152, v8
    v_and_b32 v9, 31, v0
    v_lshl_add_u32 v8, v9, 4, v8
    v_cmp_gt_u32 vcc, 8, v9
    v_mov_b32 v9, 0x7fff0000
    s_nop 0
    v_cndmask_b32 v9, v9, v8, vcc
    s_waitcnt lgkmcnt(0)
    buffer_load_dwordx4 v[10:13], v8, s[16:19], 0 offen
    buffer_load_dwordx4 v[14:17], v8, s[16:19], 0 offen offset:512
    buffer_load_dwordx4 v[18:21], v9, s[16:19], 0 offen offset:1024
    buffer_load_dwordx4 v[22:25], v8, s[16:19], s45 offen
    buffer_load_dwordx4 v[128:131], v8, s[16:19], s7 offen
L_X_nox:
    s_waitcnt lgkmcnt(0)
    buffer_load_dwordx4 v4, s[8:11], s44 offen nt lds
    s_addk_i32 m0, 1152
    s_add_u32 s44, s44, s47
    buffer_load_dwordx4 v4, s[8:11], s44 offen nt lds
    s_addk_i32 m0, 1152
    s_add_u32 s44, s44, s47
    buffer_load_dwordx4 v4, s[8:11], s44 offen nt lds
    s_addk_i32 m0, 1152
    s_add_u32 s44, s44, s47
    buffer_load_dwordx4 v4, s[8:11], s44 offen nt lds
    s_branch L_X2
L_Y:
    s_cmp_eq_u32 s3, 0
    s_cbranch_scc0 L_nopf
    s_getpc_b64 s[54:55]
    s_bfe_u32 s7, s2, 0x20003
    s_mul_i32 s7, s7, 3456
    v_lshl_add_u32 v8, v0, 7, s7
    s_mov_b64 exec, 0x7ffffff
    global_load_dword v30, v8, s[54:55] offset:512
    s_mov_b64 exec, -1
L_nopf:
    v_lshrrev_b32 v8, 1, v0
    v_and_b32 v9, 1, v0
    v_lshlrev_b32 v9, 7, v9
    v_lshl_add_u32 v8, v8, 13, v9
    s_bfe_u32 s46, s2, 0x40003
    s_cmp_lt_u32 s3, 4
    s_cbranch_scc0 L_Y_nk
    s_add_u32 s45, s2, s3
    s_and_b32 s45, s45, 7
    s_lshl3_add_u32 s45, s3, s45
    s_and_b32 s7, s45, 3
    s_cmp_eq_u32 s7, 1
    s_cselect_b32 s58, 22, 10
    s_lshr_b32 s7, s46, 2
    s_mul_i32 s7, s7, 144
    s_and_b32 s47, s46, 3
    s_sub_u32 s47, s47, 4
    s_mul_i32 s47, s47, s58
    s_add_u32 s7, s7, s47
    s_add_u32 s7, s7, 144
    s_lshl_b32 s7, s7, 5
    s_add_u32 s7, s7, s45
    s_lshl_b32 s7, s7, 8
    s_lshl_b32 s58, s58, 1
    s_bfm_b64 exec, s58, 0
    s_waitcnt lgkmcnt(0)
    s_cbranch_execz L_Y_nq0
    buffer_load_dword v31, v8, s[8:11], s7 offen
L_Y_nq0:
    s_mov_b64 exec, -1
    s_lshl_b32 s7, s46, 10
    s_add_u32 s7, s7, s45
    s_lshl_b32 s7, s7, 8
    buffer_load_dword v31, v8, s[20:23], s7 offen
L_Y_nk:
L_Y_nq:
    s_mov_b64 exec, -1
    s_waitcnt lgkmcnt(0)
    s_load_dwordx2 s[8:9], s[0:1], 8
    s_branch L_Y2
L_X2:
    s_lshr_b32 s7, s2, 5
    s_add_u32 s7, s7, 3
    s_and_b32 s7, s7, 3
    s_add_u32 s45, s2, s7
    s_and_b32 s45, s45, 7
    s_lshl3_add_u32 s100, s7, s45
    s_load_dword s41, s[12:13], 0
    v_lshlrev_b32 v8, 2, v2
    v_xor_b32 v8, v8, v3
    v_lshlrev_b32 v8, 4, v8
    v_lshl_add_u32 v5, v2, 13, v8
    s_cmp_eq_u32 s3, 8
    s_cselect_b32 s45, 3, s3
    s_lshl3_add_u32 s7, s6, s45
    s_lshl_b32 s7, s7, 9
    s_add_u32 s7, s7, s100
    s_lshl_b32 s44, s7, 8
    s_mul_i32 s7, s45, 4160
    s_add_u32 m0, s7, 55296
    s_cmp_eq_u32 s45, 3
    s_barrier
    s_cbranch_scc1 L_X_nouk
    buffer_load_dwordx4 v5, s[20:23], s44 offen nt lds
    s_addk_i32 m0, 1040
    s_add_u32 s44, s44, s47
    buffer_load_dwordx4 v5, s[20:23], s44 offen nt lds
    s_addk_i32 m0, 1040
    s_add_u32 s44, s44, s47
    buffer_load_dwordx4 v5, s[20:23], s44 offen nt lds
    s_addk_i32 m0, 1040
    s_add_u32 s44, s44, s47
    buffer_load_dwordx4 v5, s[20:23], s44 offen nt lds
L_X_nouk:
    s_load_dwordx2 s[8:9], s[0:1], 64
    s_movk_i32 s10, 9216
    s_load_dwordx2 s[24:25], s[0:1], 32
    s_load_dwordx2 s[60:61], s[0:1], 56
    s_load_dwordx2 s[28:29], s[0:1], 72
    s_load_dwordx2 s[32:33], s[0:1], 80
    s_load_dwordx2 s[36:37], s[0:1], 88
    s_mov_b32 s26, 4194304
    s_mov_b32 s27, s11
    s_mov_b32 s62, 5308416
    s_mov_b32 s63, s11
    s_mov_b32 s30, 5308416
    s_mov_b32 s31, s11
    s_mov_b32 s34, 1152
    s_mov_b32 s35, s11
    s_mov_b32 s38, 2304
    s_mov_b32 s39, s11
    s_mov_b32 s42, 0xfffff
    s_mov_b32 s43, 0xfffff000
    s_mov_b32 s57, 0xfffefffe
    s_lshr_b32 s7, s2, 5
    s_add_u32 s45, s2, s7
    s_and_b32 s45, s45, 7
    s_lshl3_add_u32 s100, s7, s45
    s_and_b32 s45, s2, 7
    s_lshl2_add_u32 s5, s45, s7
    s_lshl2_add_u32 s4, s5, s6
    s_and_b32 s53, s2, 31
    s_mul_i32 s96, s53, 43
    s_lshr_b32 s96, s96, 7
    s_mul_i32 s97, s96, 3
    s_sub_u32 s97, s53, s97
    s_add_u32 s51, s100, 2
    s_and_b32 s51, s51, 3
    s_lshl2_add_u32 s96, s96, s51
    s_lshl2_add_u32 s51, s51, s53
    s_add_u32 s51, s51, 101
    v_lshlrev_b32 v136, 3, v0
    s_lshl3_add_u32 s101, s4, s3
    s_lshl_b32 s101, s101, 7
    s_add_u32 s101, s101, 65536
    s_waitcnt lgkmcnt(0)
    s_add_u32 s41, s41, 1
    s_and_b32 s40, s41, 0xfff
    s_andn2_b32 s56, s41, s57
    v_mov_b32 v6, s41
    s_cmp_eq_u32 s3, 8
    s_cbranch_scc1 L_X_w8
    s_cmp_eq_u32 s3, 3
    s_cbranch_scc0 L_X_noln
    v_lshrrev_b32 v8, 2, v0
    v_lshlrev_b32 v8, 6, v8
    v_and_b32 v9, 1, v0
    v_lshl_add_u32 v8, v9, 5, v8
    v_bfe_u32 v9, v0, 1, 1
    v_lshl_add_u32 v8, v9, 3, v8
    v_add_u32 v134, 125952, v8
    s_waitcnt vmcnt(4)
    s_mov_b32 s45, 0x3f803f80
    v_mov_b32 v26, 0
    v_mov_b32 v27, 0
    v_dot2c_f32_bf16 v26, s45, v10
    v_dot2c_f32_bf16 v27, v10, v10
    v_dot2c_f32_bf16 v26, s45, v11
    v_dot2c_f32_bf16 v27, v11, v11
    v_dot2c_f32_bf16 v26, s45, v12
    v_dot2c_f32_bf16 v27, v12, v12
    v_dot2c_f32_bf16 v26, s45, v13
    v_dot2c_f32_bf16 v27, v13, v13
    v_dot2c_f32_bf16 v26, s45, v14
    v_dot2c_f32_bf16 v27, v14, v14
    v_dot2c_f32_bf16 v26, s45, v15
    v_dot2c_f32_bf16 v27, v15, v15
    v_dot2c_f32_bf16 v26, s45, v16
    v_dot2c_f32_bf16 v27, v16, v16
    v_dot2c_f32_bf16 v26, s45, v17
    v_dot2c_f32_bf16 v27, v17, v17
    v_dot2c_f32_bf16 v26, s45, v18
    v_dot2c_f32_bf16 v27, v18, v18
    v_dot2c_f32_bf16 v26, s45, v19
    v_dot2c_f32_bf16 v27, v19, v19
    v_dot2c_f32_bf16 v26, s45, v20
    v_dot2c_f32_bf16 v27, v20, v20
    v_dot2c_f32_bf16 v26, s45, v21
    v_dot2c_f32_bf16 v27, v21, v21
    s_nop 2
    v_add_f32_dpp v26, v26, v26 row_ror:1 row_mask:0xf bank_mask:0xf
    v_add_f32_dpp v27, v27, v27 row_ror:1 row_mask:0xf bank_mask:0xf
    s_nop 0
    v_add_f32_dpp v26, v26, v26 row_ror:2 row_mask:0xf bank_mask:0xf
    v_add_f32_dpp v27, v27, v27 row_ror:2 row_mask:0xf bank_mask:0xf
    s_nop 0
    v_add_f32_dpp v26, v26, v26 row_ror:4 row_mask:0xf bank_mask:0xf
    v_add_f32_dpp v27, v27, v27 row_ror:4 row_mask:0xf bank_mask:0xf
    s_nop 0
    v_add_f32_dpp v26, v26, v26 row_ror:8 row_mask:0xf bank_mask:0xf
    v_add_f32_dpp v27, v27, v27 row_ror:8 row_mask:0xf bank_mask:0xf
    s_nop 0
    v_mov_b32 v28, v26
    v_mov_b32 v29, v27
    s_nop 0
    v_permlane16_swap_b32 v26, v28
    v_permlane16_swap_b32 v27, v29
    v_add_f32 v26, v26, v28
    v_add_f32 v27, v27, v29
    v_mul_f32 v26, 0x3ae38e39, v26
    v_mul_f32 v27, 0x3ae38e39, v27
    v_fma_f32 v27, -v26, v26, v27
    v_max_f32 v27, 0, v27
    v_cvt_pk_bf16_f32 v26, v26, v27
    v_and_b32 v27, 0xffff0000, v26
    v_lshlrev_b32 v132, 16, v26
    v_add_f32 v27, 0x3727c5ac, v27
    v_cvt_pk_bf16_f32 v27, v27, v27
    v_and_b32 v27, 0xffff0000, v27
    v_sqrt_f32 v27, v27
    s_nop 0
    v_cvt_pk_bf16_f32 v27, v27, v27
    v_and_b32 v27, 0xffff0000, v27
    v_rcp_f32 v133, v27
    v_lshlrev_b32 v28, 16, v22
    v_and_b32 v29, 0xffff0000, v22
    v_sub_f32 v28, v28, v132
    v_sub_f32 v29, v29, v132
    v_cvt_pk_bf16_f32 v29, v28, v29
    v_lshlrev_b32 v28, 16, v29
    v_and_b32 v29, 0xffff0000, v29
    v_mul_f32 v28, v28, v133
    v_mul_f32 v29, v29, v133
    v_cvt_pk_bf16_f32 v22, v28, v29
    v_lshlrev_b32 v28, 16, v23
    v_and_b32 v29, 0xffff0000, v23
    v_sub_f32 v28, v28, v132
    v_sub_f32 v29, v29, v132
    v_cvt_pk_bf16_f32 v29, v28, v29
    v_lshlrev_b32 v28, 16, v29
    v_and_b32 v29, 0xffff0000, v29
    v_mul_f32 v28, v28, v133
    v_mul_f32 v29, v29, v133
    v_cvt_pk_bf16_f32 v23, v28, v29
    v_lshlrev_b32 v28, 16, v24
    v_and_b32 v29, 0xffff0000, v24
    v_sub_f32 v28, v28, v132
    v_sub_f32 v29, v29, v132
    v_cvt_pk_bf16_f32 v29, v28, v29
    v_lshlrev_b32 v28, 16, v29
    v_and_b32 v29, 0xffff0000, v29
    v_mul_f32 v28, v28, v133
    v_mul_f32 v29, v29, v133
    v_cvt_pk_bf16_f32 v24, v28, v29
    v_lshlrev_b32 v28, 16, v25
    v_and_b32 v29, 0xffff0000, v25
    v_sub_f32 v28, v28, v132
    v_sub_f32 v29, v29, v132
    v_cvt_pk_bf16_f32 v29, v28, v29
    v_lshlrev_b32 v28, 16, v29
    v_and_b32 v29, 0xffff0000, v29
    v_mul_f32 v28, v28, v133
    v_mul_f32 v29, v29, v133
    v_cvt_pk_bf16_f32 v25, v28, v29
    ds_write2_b64 v134, v[22:23], v[24:25] offset0:0 offset1:2
    v_lshlrev_b32 v28, 16, v128
    v_and_b32 v29, 0xffff0000, v128
    v_sub_f32 v28, v28, v132
    v_sub_f32 v29, v29, v132
    v_cvt_pk_bf16_f32 v29, v28, v29
    v_lshlrev_b32 v28, 16, v29
    v_and_b32 v29, 0xffff0000, v29
    v_mul_f32 v28, v28, v133
    v_mul_f32 v29, v29, v133
    v_cvt_pk_bf16_f32 v128, v28, v29
    v_lshlrev_b32 v28, 16, v129
    v_and_b32 v29, 0xffff0000, v129
    v_sub_f32 v28, v28, v132
    v_sub_f32 v29, v29, v132
    v_cvt_pk_bf16_f32 v29, v28, v29
    v_lshlrev_b32 v28, 16, v29
    v_and_b32 v29, 0xffff0000, v29
    v_mul_f32 v28, v28, v133
    v_mul_f32 v29, v29, v133
    v_cvt_pk_bf16_f32 v129, v28, v29
    v_lshlrev_b32 v28, 16, v130
    v_and_b32 v29, 0xffff0000, v130
    v_sub_f32 v28, v28, v132
    v_sub_f32 v29, v29, v132
    v_cvt_pk_bf16_f32 v29, v28, v29
    v_lshlrev_b32 v28, 16, v29
    v_and_b32 v29, 0xffff0000, v29
    v_mul_f32 v28, v28, v133
    v_mul_f32 v29, v29, v133
    v_cvt_pk_bf16_f32 v130, v28, v29
    v_lshlrev_b32 v28, 16, v131
    v_and_b32 v29, 0xffff0000, v131
    v_sub_f32 v28, v28, v132
    v_sub_f32 v29, v29, v132
    v_cvt_pk_bf16_f32 v29, v28, v29
    v_lshlrev_b32 v28, 16, v29
    v_and_b32 v29, 0xffff0000, v29
    v_mul_f32 v28, v28, v133
    v_mul_f32 v29, v29, v133
    v_cvt_pk_bf16_f32 v131, v28, v29
    ds_write2_b64 v134, v[128:129], v[130:131] offset0:128 offset1:130
L_X_noln:
    v_lshrrev_b32 v8, 2, v3
    v_bfe_u32 v9, v0, 1, 1
    v_lshl_add_u32 v9, s3, 1, v9
    v_lshlrev_b32 v7, 1, v8
    v_xor_b32 v9, v9, v7
    v_lshlrev_b32 v9, 4, v9
    v_lshl_add_u32 v9, v8, 8, v9
    v_and_b32 v8, 1, v0
    v_lshl_add_u32 v9, v8, 3, v9
    v_mul_u32_u24 v8, 1152, v2
    v_add_u32 v7, v8, v9
    s_lshr_b32 s7, s2, 5
    s_add_u32 s7, s7, 3
    s_and_b32 s7, s7, 3
    s_add_u32 s45, s2, s7
    s_and_b32 s45, s45, 7
    s_lshl3_add_u32 s100, s7, s45
    s_and_b32 s45, s2, 7
    s_lshl2_add_u32 s5, s45, s7
    s_lshl2_add_u32 s4, s5, s6
    v_and_b32 v8, 1, v0
    v_lshlrev_b32 v9, 9, v8
    v_lshl_add_u32 v10, v2, 4, v9
    v_add_u32 v10, 125952, v10
    v_mov_b32 v34, 0
    v_mov_b32 v35, 0
    s_waitcnt lgkmcnt(0)
    s_barrier
    ds_read_b128 v[36:39], v10 offset:0
    ds_read_b128 v[40:43], v10 offset:64
    ds_read_b128 v[44:47], v10 offset:128
    ds_read_b128 v[48:51], v10 offset:192
    ds_read_b128 v[52:55], v10 offset:256
    s_cmp_lt_u32 s3, 4
    s_cbranch_scc0 L_X_h1
    v_lshrrev_b32 v8, 2, v3
    v_mul_u32_u24 v8, 2080, v8
    v_and_b32 v9, 3, v0
    v_lshl_add_u32 v8, v9, 8, v8
    v_lshl_add_u32 v8, v2, 4, v8
    s_mul_i32 s7, s3, 8320
    s_add_u32 s7, s7, 55296
    v_add_u32 v8, s7, v8
    v_lshlrev_b32 v9, 6, v9
    v_add_u32 v56, v8, v9
    v_xor_b32 v57, 64, v9
    v_add_u32 v57, v8, v57
    v_xor_b32 v58, 0x80, v9
    v_add_u32 v58, v8, v58
    v_xor_b32 v59, 0xc0, v9
    v_add_u32 v59, v8, v59
    v_and_b32 v8, 1, v0
    v_mul_u32_u24 v9, 272, v8
    v_lshl_add_u32 v9, v2, 4, v9
    v_add_u32 v61, 128000, v9
    v_lshlrev_b32 v8, 15, v8
    v_lshl_add_u32 v62, v2, 4, v8
    s_lshl2_add_u32 s46, s4, s3
    s_lshl_b32 s46, s46, 6
    s_add_u32 s46, s46, 196608
    s_mov_b32 s48, 0x00030003
    s_mov_b32 s49, 0x00030003
    s_lshr_b32 s7, s2, 5
    s_add_u32 s7, s7, 1
    s_and_b32 s7, s7, 3
    s_add_u32 s45, s2, s7
    s_and_b32 s45, s45, 7
    s_lshl3_add_u32 s100, s7, s45
    s_and_b32 s45, s2, 7
    s_lshl2_add_u32 s5, s45, s7
    s_lshl2_add_u32 s4, s5, s6
    v_lshl_add_u32 v4, v2, 17, v135
    s_lshl_b32 s44, s6, 5
    s_add_u32 s44, s44, s3
    s_lshl_b32 s44, s44, 7
    s_add_u32 s44, s44, s100
    s_lshl_b32 s44, s44, 8
    s_mul_i32 s7, s3, 9216
    s_add_u32 m0, s7, 89088
    s_nop 0
    s_cmp_eq_u32 s3, 3
    s_cbranch_scc0 L_X_q1a
    s_waitcnt vmcnt(0)
L_X_q1a:
    s_waitcnt vmcnt(4)
    s_barrier
    ds_read_b64_tr_b16 v[16:17], v7 offset:0
    ds_read_b64_tr_b16 v[18:19], v7 offset:4608
    ds_read_b64_tr_b16 v[20:21], v7 offset:9216
    ds_read_b64_tr_b16 v[22:23], v7 offset:13824
    ds_read_b64_tr_b16 v[24:25], v7 offset:18432
    ds_read_b64_tr_b16 v[26:27], v7 offset:23040
    ds_read_b64_tr_b16 v[28:29], v7 offset:27648
    ds_read_b64_tr_b16 v[30:31], v7 offset:32256
    ds_read_b64_tr_b16 v[32:33], v7 offset:36864
    s_waitcnt lgkmcnt(7)
    v_mfma_f32_16x16x32_bf16 v[12:15], v[36:39], v[16:19], 0
    s_waitcnt lgkmcnt(5)
    v_mfma_f32_16x16x32_bf16 v[12:15], v[40:43], v[20:23], v[12:15]
    s_waitcnt lgkmcnt(3)
    v_mfma_f32_16x16x32_bf16 v[12:15], v[44:47], v[24:27], v[12:15]
    s_waitcnt lgkmcnt(1)
    v_mfma_f32_16x16x32_bf16 v[12:15], v[48:51], v[28:31], v[12:15]
    s_waitcnt lgkmcnt(0)
    v_mfma_f32_16x16x32_bf16 v[12:15], v[52:55], v[32:35], v[12:15]
    s_nop 6
    s_mov_b64 exec, 0xffff
    v_bfi_b32 v138, s43, v12, v6
    v_bfi_b32 v139, s43, v13, v6
    buffer_store_dwordx2 v[138:139], v136, s[12:15], s101 offen
    s_mov_b64 exec, -1
    s_or_b32 s101, s101, 5242880
    s_waitcnt vmcnt(0)
    s_barrier
    ds_read_b128 v[64:67], v56 offset:0
    ds_read_b128 v[68:71], v56 offset:1040
    ds_read_b128 v[72:75], v57 offset:0
    ds_read_b128 v[76:79], v57 offset:1040
    ds_read_b128 v[80:83], v58 offset:0
    ds_read_b128 v[84:87], v58 offset:1040
    ds_read_b128 v[88:91], v59 offset:0
    ds_read_b128 v[92:95], v59 offset:1040
    s_barrier
    ds_read_b128 v[36:39], v61 offset:0
    ds_read_b128 v[40:43], v61 offset:64
    ds_read_b128 v[44:47], v61 offset:128
    ds_read_b128 v[48:51], v61 offset:192
    s_waitcnt lgkmcnt(3)
    v_mfma_f32_16x16x32_bf16 v[20:23], v[64:67], v[36:39], 0
    v_mfma_f32_16x16x32_bf16 v[24:27], v[68:71], v[36:39], 0
    s_waitcnt lgkmcnt(2)
    v_mfma_f32_16x16x32_bf16 v[20:23], v[72:75], v[40:43], v[20:23]
    v_mfma_f32_16x16x32_bf16 v[24:27], v[76:79], v[40:43], v[24:27]
    s_waitcnt lgkmcnt(1)
    v_mfma_f32_16x16x32_bf16 v[20:23], v[80:83], v[44:47], v[20:23]
    v_mfma_f32_16x16x32_bf16 v[24:27], v[84:87], v[44:47], v[24:27]
    s_waitcnt lgkmcnt(0)
    v_mfma_f32_16x16x32_bf16 v[20:23], v[88:91], v[48:51], v[20:23]
    v_mfma_f32_16x16x32_bf16 v[24:27], v[92:95], v[48:51], v[24:27]
    s_nop 5
    s_mov_b64 exec, s[48:49]
    v_cvt_pk_bf16_f32 v16, v20, v21
    v_cvt_pk_bf16_f32 v17, v22, v23
    v_cvt_pk_bf16_f32 v18, v24, v25
    v_cvt_pk_bf16_f32 v19, v26, v27
    v_bfi_b32 v16, s57, v16, v6
    v_bfi_b32 v17, s57, v17, v6
    v_bfi_b32 v18, s57, v18, v6
    v_bfi_b32 v19, s57, v19, v6
    buffer_store_dwordx4 v[16:19], v62, s[12:15], s46 offen sc1
    s_mov_b64 exec, 0xffff
    buffer_store_dwordx2 v[138:139], v136, s[12:15], s101 offen sc1
    s_mov_b64 exec, -1
    s_barrier
    s_barrier
    buffer_load_dwordx4 v4, s[24:27], s44 offen nt lds
    s_addk_i32 m0, 1152
    s_add_u32 s44, s44, 8192
    buffer_load_dwordx4 v4, s[24:27], s44 offen nt lds
    s_addk_i32 m0, 1152
    s_add_u32 s44, s44, 8192
    buffer_load_dwordx4 v4, s[24:27], s44 offen nt lds
    s_addk_i32 m0, 1152
    s_add_u32 s44, s44, 8192
    buffer_load_dwordx4 v4, s[24:27], s44 offen nt lds
    s_addk_i32 m0, 1152
    s_add_u32 s44, s44, 499712
    buffer_load_dwordx4 v4, s[24:27], s44 offen nt lds
    s_addk_i32 m0, 1152
    s_add_u32 s44, s44, 8192
    buffer_load_dwordx4 v4, s[24:27], s44 offen nt lds
    s_addk_i32 m0, 1152
    s_add_u32 s44, s44, 8192
    buffer_load_dwordx4 v4, s[24:27], s44 offen nt lds
    s_addk_i32 m0, 1152
    s_add_u32 s44, s44, 8192
    buffer_load_dwordx4 v4, s[24:27], s44 offen nt lds
    s_lshl_b32 s7, s3, 1
    v_lshrrev_b32 v8, 2, v3
    v_bfe_u32 v9, v0, 1, 1
    v_lshl_add_u32 v9, s7, 1, v9
    v_lshlrev_b32 v56, 1, v8
    v_xor_b32 v9, v9, v56
    v_lshlrev_b32 v9, 4, v9
    v_lshl_add_u32 v9, v8, 8, v9
    v_and_b32 v8, 1, v0
    v_lshl_add_u32 v9, v8, 3, v9
    v_mul_u32_u24 v8, 1152, v2
    v_add_u32 v56, v8, v9
    v_add_u32 v56, 89088, v56
    v_xor_b32 v57, 32, v56
    s_lshl2_add_u32 s58, s5, s3
    s_lshl2_add_u32 s58, s58, s6
    s_lshl_b32 s58, s58, 8
    s_add_u32 s58, s58, 262144
    v_and_b32 v8, 3, v0
    v_mul_u32_u24 v9, 272, v8
    v_lshl_add_u32 v9, v2, 4, v9
    v_add_u32 v60, 129024, v9
    s_and_b32 s50, s3, 1
    s_lshr_b32 s52, s3, 1
    s_lshl1_add_u32 s50, s50, s52
    s_lshl2_add_u32 s45, s4, s50
    s_lshl_b32 s45, s45, 12
    s_add_u32 s45, s45, 3145728
    s_lshl_b32 s7, s50, 6
    s_add_u32 s7, s7, 132480
    v_lshl_add_u32 v62, v2, 4, s7
    v_lshlrev_b32 v8, 4, v3
    v_lshl_add_u32 v96, v2, 10, v8
    v_lshl_add_u32 v8, v2, 3, v8
    s_mul_i32 s59, s3, 272
    s_add_u32 s59, s59, 129024
    v_add_u32 v97, s59, v8
    v_and_b32 v8, 1, v0
    v_lshlrev_b32 v8, 4, v8
    v_mov_b32 v9, 0xffff
    v_lshlrev_b32 v9, v8, v9
    s_mov_b32 vcc_lo, 0x03030303
    s_mov_b32 vcc_hi, 0x03030303
    v_cndmask_b32 v100, 0, v9, vcc
    s_mov_b32 vcc_lo, 0x0c0c0c0c
    s_mov_b32 vcc_hi, 0x0c0c0c0c
    v_cndmask_b32 v101, 0, v9, vcc
    s_mov_b32 vcc_lo, 0x30303030
    s_mov_b32 vcc_hi, 0x30303030
    v_cndmask_b32 v102, 0, v9, vcc
    s_mov_b32 vcc_lo, 0xc0c0c0c0
    s_mov_b32 vcc_hi, 0xc0c0c0c0
    v_cndmask_b32 v103, 0, v9, vcc
    s_barrier
    s_barrier
    s_waitcnt vmcnt(0)
    s_barrier
    s_barrier
    buffer_load_dwordx4 v[36:39], v96, s[12:15], s45 offen offset:0 sc1
    buffer_load_dwordx4 v[40:43], v96, s[12:15], s45 offen offset:256 sc1
    buffer_load_dwordx4 v[44:47], v96, s[12:15], s45 offen offset:512 sc1
    buffer_load_dwordx4 v[48:51], v96, s[12:15], s45 offen offset:768 sc1
    s_waitcnt vmcnt(4)
    s_barrier
    ds_read_b128 v[20:23], v62
    ds_read_b64_tr_b16 v[64:65], v56 offset:0
    ds_read_b64_tr_b16 v[66:67], v56 offset:4608
    ds_read_b64_tr_b16 v[68:69], v57 offset:0
    ds_read_b64_tr_b16 v[70:71], v57 offset:4608
    ds_read_b64_tr_b16 v[72:73], v56 offset:9216
    ds_read_b64_tr_b16 v[74:75], v56 offset:13824
    ds_read_b64_tr_b16 v[76:77], v57 offset:9216
    ds_read_b64_tr_b16 v[78:79], v57 offset:13824
    ds_read_b64_tr_b16 v[80:81], v56 offset:18432
    ds_read_b64_tr_b16 v[82:83], v56 offset:23040
    ds_read_b64_tr_b16 v[84:85], v57 offset:18432
    ds_read_b64_tr_b16 v[86:87], v57 offset:23040
    ds_read_b64_tr_b16 v[88:89], v56 offset:27648
    ds_read_b64_tr_b16 v[90:91], v56 offset:32256
    ds_read_b64_tr_b16 v[92:93], v57 offset:27648
    ds_read_b64_tr_b16 v[94:95], v57 offset:32256
    s_waitcnt lgkmcnt(15)
    v_and_b32 v104, v20, v100
    v_and_b32 v105, v20, v101
    v_and_b32 v106, v20, v102
    v_and_b32 v107, v20, v103
    v_and_b32 v108, v21, v100
    v_and_b32 v109, v21, v101
    v_and_b32 v110, v21, v102
    v_and_b32 v111, v21, v103
    v_and_b32 v112, v22, v100
    v_and_b32 v113, v22, v101
    v_and_b32 v114, v22, v102
    v_and_b32 v115, v22, v103
    v_and_b32 v116, v23, v100
    v_and_b32 v117, v23, v101
    v_and_b32 v118, v23, v102
    v_and_b32 v119, v23, v103
    s_branch L_h3in_2
L_h3_1:
    buffer_load_dwordx4 v[36:39], v96, s[12:15], s45 offen offset:0 sc1
    buffer_load_dwordx4 v[40:43], v96, s[12:15], s45 offen offset:256 sc1
    buffer_load_dwordx4 v[44:47], v96, s[12:15], s45 offen offset:512 sc1
    buffer_load_dwordx4 v[48:51], v96, s[12:15], s45 offen offset:768 sc1
    s_sub_u32 s42, s42, 1
    s_cbranch_scc1 L_END
L_h3in_2:
    s_waitcnt vmcnt(3)
    v_xor_b32 v36, s56, v36
    v_xor_b32 v37, s56, v37
    v_xor_b32 v38, s56, v38
    v_xor_b32 v39, s56, v39
    v_or3_b32 v8, v36, v37, v38
    v_or_b32 v8, v8, v39
    v_mfma_f32_16x16x32_bf16 v[12:15], v[104:107], v[36:39], 0
    s_waitcnt vmcnt(2)
    v_xor_b32 v40, s56, v40
    v_xor_b32 v41, s56, v41
    v_xor_b32 v42, s56, v42
    v_xor_b32 v43, s56, v43
    v_or3_b32 v8, v8, v40, v41
    v_or3_b32 v8, v8, v42, v43
    v_mfma_f32_16x16x32_bf16 v[12:15], v[108:111], v[40:43], v[12:15]
    s_waitcnt vmcnt(1)
    v_xor_b32 v44, s56, v44
    v_xor_b32 v45, s56, v45
    v_xor_b32 v46, s56, v46
    v_xor_b32 v47, s56, v47
    v_or3_b32 v8, v8, v44, v45
    v_or3_b32 v8, v8, v46, v47
    v_mfma_f32_16x16x32_bf16 v[12:15], v[112:115], v[44:47], v[12:15]
    s_waitcnt vmcnt(0)
    v_xor_b32 v48, s56, v48
    v_xor_b32 v49, s56, v49
    v_xor_b32 v50, s56, v50
    v_xor_b32 v51, s56, v51
    v_or3_b32 v8, v8, v48, v49
    v_or3_b32 v8, v8, v50, v51
    v_mfma_f32_16x16x32_bf16 v[12:15], v[116:119], v[48:51], v[12:15]
    v_and_b32 v8, 0x10001, v8
    v_cmp_ne_u32 vcc, 0, v8
    s_nop 3
    s_cbranch_vccnz L_h3_1
    s_mov_b32 exec_hi, 0
    v_cvt_pk_bf16_f32 v12, v12, v13
    v_cvt_pk_bf16_f32 v13, v14, v15
    ds_write_b64 v97, v[12:13]
    s_mov_b32 exec_hi, -1
    s_waitcnt lgkmcnt(0)
    s_barrier
    ds_read_b128 v[36:39], v60 offset:0
    ds_read_b128 v[40:43], v60 offset:64
    ds_read_b128 v[44:47], v60 offset:128
    ds_read_b128 v[48:51], v60 offset:192
    s_mov_b32 vcc_lo, 0xffff0000
    s_mov_b32 vcc_hi, 0
    s_waitcnt lgkmcnt(3)
    v_mfma_f32_16x16x32_bf16 v[12:15], v[36:39], v[64:67], 0
    v_mfma_f32_16x16x32_bf16 v[16:19], v[36:39], v[68:71], 0
    s_waitcnt lgkmcnt(2)
    v_mfma_f32_16x16x32_bf16 v[12:15], v[40:43], v[72:75], v[12:15]
    v_mfma_f32_16x16x32_bf16 v[16:19], v[40:43], v[76:79], v[16:19]
    s_waitcnt lgkmcnt(1)
    v_mfma_f32_16x16x32_bf16 v[12:15], v[44:47], v[80:83], v[12:15]
    v_mfma_f32_16x16x32_bf16 v[16:19], v[44:47], v[84:87], v[16:19]
    s_waitcnt lgkmcnt(0)
    v_mfma_f32_16x16x32_bf16 v[12:15], v[48:51], v[88:91], v[12:15]
    v_mfma_f32_16x16x32_bf16 v[16:19], v[48:51], v[92:95], v[16:19]
    s_nop 5
    s_mov_b32 exec_hi, 0
    v_add_f32 v12, v12, v14
    v_add_f32 v13, v13, v15
    v_add_f32 v16, v16, v18
    v_add_f32 v17, v17, v19
    v_cndmask_b32 v12, v12, v16, vcc
    v_cndmask_b32 v13, v13, v17, vcc
    v_bfi_b32 v12, s43, v12, v6
    v_bfi_b32 v13, s43, v13, v6
    buffer_store_dwordx2 v[12:13], v136, s[12:15], s58 offen
    s_or_b32 s58, s58, 5242880
    buffer_store_dwordx2 v[12:13], v136, s[12:15], s58 offen sc1
    s_mov_b32 exec_hi, -1
    s_branch L_X_post
L_X_h1:
    v_and_b32 v8, 1, v2
    v_lshl_add_u32 v8, v3, 1, v8
    v_lshrrev_b32 v9, 1, v2
    v_mul_u32_u24 v9, 272, v9
    v_lshl_add_u32 v8, v8, 1, v9
    v_add_u32 v60, 127744, v8
    v_lshl_add_u32 v60, s3, 6, v60
    v_lshlrev_b32 v8, 4, v3
    v_lshl_add_u32 v61, v2, 10, v8
    s_lshl4_add_u32 s46, s5, s3
    s_lshl_b32 s46, s46, 8
    s_add_u32 s46, s46, 64512
    s_sub_u32 s59, s3, 4
    s_mul_i32 s7, s59, 9
    v_lshrrev_b32 v8, 3, v0
    v_lshl_add_u32 v8, s7, 3, v8
    v_mul_u32_u24 v8, 57, v8
    v_bfe_u32 v9, v8, 10, 1
    v_bfe_u32 v64, v8, 12, 1
    v_lshl_add_u32 v9, v64, 1, v9
    v_lshlrev_b32 v9, 5, v9
    v_xor_b32 v64, v9, v1
    v_add_u32 v8, 456, v8
    v_bfe_u32 v9, v8, 10, 1
    v_bfe_u32 v65, v8, 12, 1
    v_lshl_add_u32 v9, v65, 1, v9
    v_lshlrev_b32 v9, 5, v9
    v_xor_b32 v65, v9, v1
    v_add_u32 v8, 456, v8
    v_bfe_u32 v9, v8, 10, 1
    v_bfe_u32 v66, v8, 12, 1
    v_lshl_add_u32 v9, v66, 1, v9
    v_lshlrev_b32 v9, 5, v9
    v_xor_b32 v66, v9, v1
    v_add_u32 v8, 456, v8
    v_bfe_u32 v9, v8, 10, 1
    v_bfe_u32 v67, v8, 12, 1
    v_lshl_add_u32 v9, v67, 1, v9
    v_lshlrev_b32 v9, 5, v9
    v_xor_b32 v67, v9, v1
    v_add_u32 v8, 456, v8
    v_bfe_u32 v9, v8, 10, 1
    v_bfe_u32 v68, v8, 12, 1
    v_lshl_add_u32 v9, v68, 1, v9
    v_lshlrev_b32 v9, 5, v9
    v_xor_b32 v68, v9, v1
    v_add_u32 v8, 456, v8
    v_bfe_u32 v9, v8, 10, 1
    v_bfe_u32 v69, v8, 12, 1
    v_lshl_add_u32 v9, v69, 1, v9
    v_lshlrev_b32 v9, 5, v9
    v_xor_b32 v69, v9, v1
    v_add_u32 v8, 456, v8
    v_bfe_u32 v9, v8, 10, 1
    v_bfe_u32 v70, v8, 12, 1
    v_lshl_add_u32 v9, v70, 1, v9
    v_lshlrev_b32 v9, 5, v9
    v_xor_b32 v70, v9, v1
    v_add_u32 v8, 456, v8
    v_bfe_u32 v9, v8, 10, 1
    v_bfe_u32 v71, v8, 12, 1
    v_lshl_add_u32 v9, v71, 1, v9
    v_lshlrev_b32 v9, 5, v9
    v_xor_b32 v71, v9, v1
    v_add_u32 v8, 456, v8
    v_bfe_u32 v9, v8, 10, 1
    v_bfe_u32 v72, v8, 12, 1
    v_lshl_add_u32 v9, v72, 1, v9
    v_lshlrev_b32 v9, 5, v9
    v_xor_b32 v72, v9, v1
    v_mul_u32_u24 v9, 9216, v2
    v_add_u32 v5, v135, v9
    s_cmp_lt_u32 s53, 27
    s_cbranch_scc1 L_X_a1
    s_lshl_b32 m0, s7, 10
    s_mul_i32 s44, s51, 36864
    s_add_u32 s44, s44, m0
    s_branch L_X_a2
L_X_a1:
    s_mul_i32 s44, s97, 48
    s_add_u32 s44, s44, s59
    s_mul_i32 s44, s44, 36864
    s_lshl_b32 s7, s96, 8
    s_add_u32 s44, s44, s7
    s_mul_i32 m0, s59, 1152
    s_mov_b32 s47, 147456
L_X_a2:
    s_waitcnt vmcnt(4)
    s_barrier
    ds_read_b64_tr_b16 v[16:17], v7 offset:0
    ds_read_b64_tr_b16 v[18:19], v7 offset:4608
    ds_read_b64_tr_b16 v[20:21], v7 offset:9216
    ds_read_b64_tr_b16 v[22:23], v7 offset:13824
    ds_read_b64_tr_b16 v[24:25], v7 offset:18432
    ds_read_b64_tr_b16 v[26:27], v7 offset:23040
    ds_read_b64_tr_b16 v[28:29], v7 offset:27648
    ds_read_b64_tr_b16 v[30:31], v7 offset:32256
    ds_read_b64_tr_b16 v[32:33], v7 offset:36864
    s_waitcnt lgkmcnt(7)
    v_mfma_f32_16x16x32_bf16 v[12:15], v[36:39], v[16:19], 0
    s_waitcnt lgkmcnt(5)
    v_mfma_f32_16x16x32_bf16 v[12:15], v[40:43], v[20:23], v[12:15]
    s_waitcnt lgkmcnt(3)
    v_mfma_f32_16x16x32_bf16 v[12:15], v[44:47], v[24:27], v[12:15]
    s_waitcnt lgkmcnt(1)
    v_mfma_f32_16x16x32_bf16 v[12:15], v[48:51], v[28:31], v[12:15]
    s_waitcnt lgkmcnt(0)
    v_mfma_f32_16x16x32_bf16 v[12:15], v[52:55], v[32:35], v[12:15]
    s_nop 6
    s_mov_b64 exec, 0xffff
    v_bfi_b32 v138, s43, v12, v6
    v_bfi_b32 v139, s43, v13, v6
    buffer_store_dwordx2 v[138:139], v136, s[12:15], s101 offen
    s_mov_b64 exec, -1
    s_or_b32 s101, s101, 5242880
    s_or_b32 s42, s42, 31
    buffer_load_dwordx4 v[16:19], v61, s[12:15], s46 offen sc1
    s_waitcnt vmcnt(1)
    s_barrier
    s_branch L_g32_3_in
L_g32_3:
    buffer_load_dwordx4 v[16:19], v61, s[12:15], s46 offen sc1
    s_sub_u32 s42, s42, 1
    s_cbranch_scc1 L_END
    s_andn2_b32 s46, s46, 5242880
    s_and_b32 s7, s42, 31
    s_cselect_b32 s7, 0, 5242880
    s_add_u32 s46, s46, s7
    s_cmp_eq_u32 s7, 0
    s_cbranch_scc1 L_X_nfb
    s_waitcnt vmcnt(0)
    s_and_b32 s45, s101, 0xfffffc00
    s_lshl_b32 s7, s59, 8
    s_add_u32 s45, s45, s7
    s_andn2_b32 s7, s45, 5242880
    s_mov_b64 exec, 0xffff
    buffer_load_dwordx4 v[20:23], v1, s[12:15], s7 offen sc1
    s_waitcnt vmcnt(0)
    buffer_store_dwordx4 v[20:23], v1, s[12:15], s45 offen sc1
    s_mov_b64 exec, -1
L_X_nfb:
L_g32_3_in:
    s_waitcnt vmcnt(0)
L_g32_3_chk:
    v_xor_b32 v16, s40, v16
    v_xor_b32 v17, s40, v17
    v_xor_b32 v18, s40, v18
    v_xor_b32 v19, s40, v19
    v_or3_b32 v8, v16, v17, v18
    v_or_b32 v8, v8, v19
    v_and_b32 v8, 0xfff, v8
    v_cmp_ne_u32 vcc, 0, v8
    v_permlane32_swap_b32 v16, v17
    v_permlane32_swap_b32 v18, v19
    s_cbranch_vccnz L_g32_3
    v_add_f32 v16, v16, v17
    v_add_f32 v18, v18, v19
    s_nop 1
    v_permlane16_swap_b32 v16, v18
    v_add_f32 v16, v16, v18
    v_cvt_pk_bf16_f32 v16, v16, v16
    ds_write_b16 v60, v16 offset:0
    s_waitcnt lgkmcnt(0)
    s_barrier
    s_mov_b64 exec, 0xffff
    buffer_store_dwordx2 v[138:139], v136, s[12:15], s101 offen sc1
    s_mov_b64 exec, -1
    s_cmp_lt_u32 s53, 27
    s_cbranch_scc0 L_X_nof1
    s_barrier
    buffer_load_dwordx4 v5, s[60:63], s44 offen nt lds
    s_addk_i32 m0, 4608
    s_add_u32 s44, s44, s47
    buffer_load_dwordx4 v5, s[60:63], s44 offen nt lds
    s_addk_i32 m0, 4608
    s_add_u32 s44, s44, s47
    buffer_load_dwordx4 v5, s[60:63], s44 offen nt lds
    s_addk_i32 m0, 4608
    s_add_u32 s44, s44, s47
    buffer_load_dwordx4 v5, s[60:63], s44 offen nt lds
    s_addk_i32 m0, 4608
    s_add_u32 s44, s44, s47
    buffer_load_dwordx4 v5, s[60:63], s44 offen nt lds
    s_addk_i32 m0, 4608
    s_add_u32 s44, s44, s47
    buffer_load_dwordx4 v5, s[60:63], s44 offen nt lds
    s_addk_i32 m0, 4608
    s_add_u32 s44, s44, s47
    buffer_load_dwordx4 v5, s[60:63], s44 offen nt lds
    s_addk_i32 m0, 4608
    s_add_u32 s44, s44, s47
    buffer_load_dwordx4 v5, s[60:63], s44 offen nt lds
    s_addk_i32 m0, 4608
    s_add_u32 s44, s44, s47
    buffer_load_dwordx4 v5, s[60:63], s44 offen nt lds
    s_addk_i32 m0, 4608
    s_add_u32 s44, s44, s47
    buffer_load_dwordx4 v5, s[60:63], s44 offen nt lds
    s_addk_i32 m0, 4608
    s_add_u32 s44, s44, s47
    buffer_load_dwordx4 v5, s[60:63], s44 offen nt lds
    s_addk_i32 m0, 4608
    s_add_u32 s44, s44, s47
    buffer_load_dwordx4 v5, s[60:63], s44 offen nt lds
    s_barrier
    s_barrier
    s_lshl_b32 s7, s59, 1
    v_lshrrev_b32 v8, 2, v3
    v_bfe_u32 v9, v0, 1, 1
    v_lshl_add_u32 v9, s7, 1, v9
    v_lshlrev_b32 v56, 1, v8
    v_xor_b32 v9, v9, v56
    v_lshlrev_b32 v9, 4, v9
    v_lshl_add_u32 v9, v8, 8, v9
    v_and_b32 v8, 1, v0
    v_lshl_add_u32 v9, v8, 3, v9
    v_mul_u32_u24 v8, 1152, v2
    v_add_u32 v56, v8, v9
    ds_read_b128 v[140:143], v10 offset:1024
    ds_read_b128 v[144:147], v10 offset:1088
    ds_read_b128 v[148:151], v10 offset:1152
    ds_read_b128 v[152:155], v10 offset:1216
    ds_read_b128 v[156:159], v10 offset:1280
    ds_read_b128 v[160:163], v10 offset:1344
    v_xor_b32 v57, 32, v56
    s_lshl2_add_u32 s46, s96, s59
    s_lshl2_add_u32 s46, s46, s97
    s_lshl_b32 s46, s46, 8
    s_add_u32 s46, s46, 393216
    s_waitcnt vmcnt(0)
    s_barrier
    ds_read_b64_tr_b16 v[80:81], v56 offset:0
    ds_read_b64_tr_b16 v[82:83], v56 offset:4608
    ds_read_b64_tr_b16 v[84:85], v57 offset:0
    ds_read_b64_tr_b16 v[86:87], v57 offset:4608
    ds_read_b64_tr_b16 v[88:89], v56 offset:9216
    ds_read_b64_tr_b16 v[90:91], v56 offset:13824
    ds_read_b64_tr_b16 v[92:93], v57 offset:9216
    ds_read_b64_tr_b16 v[94:95], v57 offset:13824
    ds_read_b64_tr_b16 v[96:97], v56 offset:18432
    ds_read_b64_tr_b16 v[98:99], v56 offset:23040
    ds_read_b64_tr_b16 v[100:101], v57 offset:18432
    ds_read_b64_tr_b16 v[102:103], v57 offset:23040
    ds_read_b64_tr_b16 v[104:105], v56 offset:27648
    ds_read_b64_tr_b16 v[106:107], v56 offset:32256
    ds_read_b64_tr_b16 v[108:109], v57 offset:27648
    ds_read_b64_tr_b16 v[110:111], v57 offset:32256
    ds_read_b64_tr_b16 v[112:113], v56 offset:36864
    ds_read_b64_tr_b16 v[114:115], v56 offset:41472
    ds_read_b64_tr_b16 v[116:117], v57 offset:36864
    ds_read_b64_tr_b16 v[118:119], v57 offset:41472
    ds_read_b64_tr_b16 v[120:121], v56 offset:46080
    ds_read_b64_tr_b16 v[122:123], v56 offset:50688
    ds_read_b64_tr_b16 v[124:125], v57 offset:46080
    ds_read_b64_tr_b16 v[126:127], v57 offset:50688
    s_waitcnt lgkmcnt(15)
    v_mfma_f32_16x16x32_bf16 v[12:15], v[140:143], v[80:83], 0
    v_mfma_f32_16x16x32_bf16 v[16:19], v[140:143], v[84:87], 0
    s_waitcnt lgkmcnt(15)
    v_mfma_f32_16x16x32_bf16 v[12:15], v[144:147], v[88:91], v[12:15]
    v_mfma_f32_16x16x32_bf16 v[16:19], v[144:147], v[92:95], v[16:19]
    s_waitcnt lgkmcnt(12)
    v_mfma_f32_16x16x32_bf16 v[12:15], v[148:151], v[96:99], v[12:15]
    v_mfma_f32_16x16x32_bf16 v[16:19], v[148:151], v[100:103], v[16:19]
    s_waitcnt lgkmcnt(8)
    v_mfma_f32_16x16x32_bf16 v[12:15], v[152:155], v[104:107], v[12:15]
    v_mfma_f32_16x16x32_bf16 v[16:19], v[152:155], v[108:111], v[16:19]
    s_waitcnt lgkmcnt(4)
    v_mfma_f32_16x16x32_bf16 v[12:15], v[156:159], v[112:115], v[12:15]
    v_mfma_f32_16x16x32_bf16 v[16:19], v[156:159], v[116:119], v[16:19]
    s_waitcnt lgkmcnt(0)
    v_mfma_f32_16x16x32_bf16 v[12:15], v[160:163], v[120:123], v[12:15]
    v_mfma_f32_16x16x32_bf16 v[16:19], v[160:163], v[124:127], v[16:19]
    s_mov_b32 vcc_lo, 0xffff0000
    s_mov_b32 vcc_hi, 0
    s_nop 4
    s_mov_b32 exec_hi, 0
    v_cndmask_b32 v12, v12, v16, vcc
    v_cndmask_b32 v13, v13, v17, vcc
    v_bfi_b32 v12, s43, v12, v6
    v_bfi_b32 v13, s43, v13, v6
    buffer_store_dwordx2 v[12:13], v136, s[12:15], s46 offen sc1
    s_mov_b32 exec_hi, -1
    s_barrier
    s_barrier
    s_barrier
    s_barrier
    s_branch L_X_post
L_X_nof1:
    s_cmp_lt_u32 s53, 31
    s_cbranch_scc0 L_EXIT
L_X_f2s:
    s_barrier
    buffer_load_dwordx4 v64, s[28:31], s44 offen offset:0 nt lds
    buffer_load_dwordx4 v65, s[28:31], s44 offen offset:1024 nt lds
    buffer_load_dwordx4 v66, s[28:31], s44 offen offset:2048 nt lds
    buffer_load_dwordx4 v67, s[28:31], s44 offen offset:3072 nt lds
    s_addk_i32 m0, 4096
    s_addk_i32 s44, 4096
    buffer_load_dwordx4 v68, s[28:31], s44 offen offset:0 nt lds
    buffer_load_dwordx4 v69, s[28:31], s44 offen offset:1024 nt lds
    buffer_load_dwordx4 v70, s[28:31], s44 offen offset:2048 nt lds
    buffer_load_dwordx4 v71, s[28:31], s44 offen offset:3072 nt lds
    s_addk_i32 m0, 4096
    s_addk_i32 s44, 4096
    buffer_load_dwordx4 v72, s[28:31], s44 offen offset:0 nt lds
    v_lshlrev_b32 v55, 2, v0
    s_barrier
    s_barrier
    s_waitcnt vmcnt(0)
    s_barrier
    s_barrier
    s_lshl_b32 s96, s59, 1
    v_lshrrev_b32 v8, 2, v3
    v_lshl_add_u32 v9, v2, 3, v8
    v_mul_u32_u24 v9, 1152, v9
    v_lshl_add_u32 v9, s96, 7, v9
    v_and_b32 v56, 3, v0
    v_lshl_add_u32 v9, v56, 3, v9
    v_lshrrev_b32 v8, 1, v8
    v_and_b32 v56, 1, v2
    v_lshl_add_u32 v8, v56, 1, v8
    v_lshl_add_u32 v56, v8, 5, v9
    v_xor_b32 v57, 32, v56
    v_xor_b32 v58, 64, v56
    v_xor_b32 v59, 0x60, v56
    ds_read_b64_tr_b16 v[80:81], v56 offset:0
    ds_read_b64_tr_b16 v[82:83], v56 offset:4608
    ds_read_b64_tr_b16 v[84:85], v57 offset:0
    ds_read_b64_tr_b16 v[86:87], v57 offset:4608
    ds_read_b64_tr_b16 v[88:89], v58 offset:0
    ds_read_b64_tr_b16 v[90:91], v58 offset:4608
    ds_read_b64_tr_b16 v[92:93], v59 offset:0
    ds_read_b64_tr_b16 v[94:95], v59 offset:4608
    ds_read_b64_tr_b16 v[96:97], v56 offset:128
    ds_read_b64_tr_b16 v[98:99], v56 offset:4736
    ds_read_b64_tr_b16 v[100:101], v57 offset:128
    ds_read_b64_tr_b16 v[102:103], v57 offset:4736
    ds_read_b64_tr_b16 v[104:105], v58 offset:128
    ds_read_b64_tr_b16 v[106:107], v58 offset:4736
    ds_read_b64_tr_b16 v[108:109], v59 offset:128
    ds_read_b64_tr_b16 v[110:111], v59 offset:4736
    v_lshlrev_b32 v63, 2, v3
    s_lshl_b32 s7, s51, 6
    s_lshl_b32 s45, s51, 10
    s_add_u32 s45, s45, 393216
    buffer_load_dword v28, v63, s[8:11], s7 offen
    s_mov_b32 s97, s45
    v_and_b32 v8, 1, v0
    v_lshlrev_b32 v8, 6, v8
    v_lshl_add_u32 v8, v2, 4, v8
    v_add_u32 v61, 131840, v8
    v_and_b32 v8, 1, v2
    v_lshl_add_u32 v8, v3, 1, v8
    v_lshrrev_b32 v9, 1, v2
    v_mul_u32_u24 v9, 64, v9
    v_lshl_add_u32 v8, v8, 1, v9
    v_add_u32 v60, 131840, v8
    v_lshl_add_u32 v60, s59, 7, v60
    v_lshl_add_u32 v61, s59, 7, v61
    s_mul_i32 s47, s51, 2432
    s_lshl_b32 s58, s59, 9
    s_add_u32 s47, s47, s58
    s_add_u32 s47, s47, 1048576
    s_mov_b32 s98, 0xffff0000
    s_mov_b32 s99, 0xffff0000
    s_mov_b32 s48, 0
    s_mov_b32 s49, -1
    s_barrier
    s_barrier
    s_waitcnt vmcnt(0)
    v_lshlrev_b32 v16, 16, v28
    v_lshlrev_b32 v17, 16, v28
    v_and_b32 v18, 0xffff0000, v28
    v_and_b32 v19, 0xffff0000, v28
    s_mov_b32 exec_hi, 0xffff
    buffer_load_dwordx4 v[16:19], v1, s[12:15], s97 offen sc1
    s_barrier
    s_branch L_g32_4_in
L_g32_4:
    buffer_load_dwordx4 v[16:19], v1, s[12:15], s97 offen sc1
    s_sub_u32 s42, s42, 1
    s_cbranch_scc1 L_END
L_g32_4_in:
    s_waitcnt vmcnt(0)
L_g32_4_chk:
    v_xor_b32 v16, s40, v16
    v_xor_b32 v17, s40, v17
    v_xor_b32 v18, s40, v18
    v_xor_b32 v19, s40, v19
    v_or3_b32 v8, v16, v17, v18
    v_or_b32 v8, v8, v19
    v_and_b32 v8, 0xfff, v8
    v_cmp_ne_u32 vcc, 0, v8
    s_nop 1
    s_cbranch_vccnz L_g32_4
    s_mov_b32 exec_hi, -1
    v_permlane32_swap_b32 v16, v17
    v_permlane32_swap_b32 v18, v19
    v_add_f32 v16, v16, v17
    v_add_f32 v18, v18, v19
    s_nop 1
    v_permlane16_swap_b32 v16, v18
    v_add_f32 v16, v16, v18
    v_max_f32 v16, 0, v16
    v_mul_f32 v16, v16, v16
    v_cvt_pk_bf16_f32 v16, v16, v16
    ds_write_b16 v60, v16 offset:0
    ds_read_b128 v[20:23], v61
    s_waitcnt lgkmcnt(0)
    v_mfma_f32_16x16x32_bf16 v[112:115], v[20:23], v[80:83], 0
    v_mfma_f32_16x16x32_bf16 v[116:119], v[20:23], v[84:87], 0
    v_mfma_f32_16x16x32_bf16 v[120:123], v[20:23], v[88:91], 0
    v_mfma_f32_16x16x32_bf16 v[124:127], v[20:23], v[92:95], 0
    v_mfma_f32_16x16x32_bf16 v[128:131], v[20:23], v[96:99], 0
    v_mfma_f32_16x16x32_bf16 v[132:135], v[20:23], v[100:103], 0
    v_mfma_f32_16x16x32_bf16 v[136:139], v[20:23], v[104:107], 0
    v_mfma_f32_16x16x32_bf16 v[140:143], v[20:23], v[108:111], 0
    s_nop 7
    v_cndmask_b32 v112, v112, v116, s[98:99]
    v_cndmask_b32 v113, v113, v117, s[98:99]
    v_cndmask_b32 v120, v120, v124, s[98:99]
    v_cndmask_b32 v121, v121, v125, s[98:99]
    v_cndmask_b32 v112, v112, v120, s[48:49]
    v_cndmask_b32 v113, v113, v121, s[48:49]
    v_add_u32 v112, 0x8000, v112
    v_add_u32 v113, 0x8000, v113
    v_cvt_pk_bf16_f32 v112, v112, v113
    v_bfi_b32 v112, s57, v112, v6
    buffer_store_dword v112, v55, s[12:15], s47 offen offset:0 sc1
    v_cndmask_b32 v128, v128, v132, s[98:99]
    v_cndmask_b32 v129, v129, v133, s[98:99]
    v_cndmask_b32 v136, v136, v140, s[98:99]
    v_cndmask_b32 v137, v137, v141, s[98:99]
    v_cndmask_b32 v128, v128, v136, s[48:49]
    v_cndmask_b32 v129, v129, v137, s[48:49]
    v_add_u32 v128, 0x8000, v128
    v_add_u32 v129, 0x8000, v129
    v_cvt_pk_bf16_f32 v128, v128, v129
    v_bfi_b32 v128, s57, v128, v6
    buffer_store_dword v128, v55, s[12:15], s47 offen offset:256 sc1
    s_branch L_END
L_X_w8:
    s_lshr_b32 s7, s2, 5
    s_add_u32 s7, s7, 1
    s_and_b32 s7, s7, 3
    s_add_u32 s45, s2, s7
    s_and_b32 s45, s45, 7
    s_lshl3_add_u32 s100, s7, s45
    s_and_b32 s45, s2, 7
    s_lshl2_add_u32 s5, s45, s7
    s_lshl2_add_u32 s4, s5, s6
    s_lshr_b32 s45, s5, 2
    v_lshrrev_b32 v8, 2, v0
    v_add_u32 v8, s45, v8
    v_and_b32 v8, 3, v8
    v_lshl_add_u32 v8, v0, 2, v8
    v_lshlrev_b32 v62, 7, v8
    s_lshr_b32 s46, s5, 4
    s_lshl_b32 s46, s46, 11
    s_and_b32 s45, s5, 3
    s_add_u32 s46, s46, s45
    s_lshl_b32 s46, s46, 4
    s_add_u32 s46, s46, 589824
    s_barrier
    s_waitcnt vmcnt(0)
    s_barrier
    buffer_load_dwordx4 v5, s[20:23], s44 offen nt lds
    s_addk_i32 m0, 1040
    s_add_u32 s44, s44, s47
    buffer_load_dwordx4 v5, s[20:23], s44 offen nt lds
    s_addk_i32 m0, 1040
    s_add_u32 s44, s44, s47
    buffer_load_dwordx4 v5, s[20:23], s44 offen nt lds
    s_addk_i32 m0, 1040
    s_add_u32 s44, s44, s47
    buffer_load_dwordx4 v5, s[20:23], s44 offen nt lds
    s_waitcnt vmcnt(0)
    s_barrier
    s_barrier
    s_lshr_b32 s7, s2, 3
    s_mul_i32 s7, s7, 21888
    s_add_u32 s7, s7, 1048576
    s_and_b32 s45, s2, 7
    v_mul_u32_u24 v8, 43, v0
    v_lshrrev_b32 v8, 7, v8
    v_mul_u32_u24 v9, 3, v8
    v_sub_u32 v9, v0, v9
    v_lshl_add_u32 v9, v9, 3, s45
    v_cmp_gt_u32 vcc, 18, v9
    v_mul_u32_u24 v8, 2432, v8
    v_lshl_add_u32 v8, v9, 7, v8
    s_and_b32 exec_lo, vcc_lo, 0x7ffffff
    s_mov_b32 exec_hi, 0
    buffer_load_dword v45, v8, s[12:15], s7 offen sc1
    s_mov_b64 exec, -1
    s_lshr_b32 s7, s2, 1
    s_and_b32 s7, s7, 60
    s_lshl_b64 exec, 15, s7
    buffer_load_dword v44, v62, s[12:15], s46 offen sc1
    s_and_b32 s7, s2, 7
    s_lshr_b32 s45, s2, 3
    s_lshl4_add_u32 s7, s7, s45
    s_lshl_b32 s7, s7, 10
    s_add_u32 s45, s7, 262144
    s_mov_b64 exec, -1
    buffer_load_dwordx4 v[40:43], v1, s[12:15], s45 offen sc1
    s_lshl_b32 s7, s2, 10
    s_add_u32 s45, s7, 393216
    buffer_load_dwordx4 v[40:43], v1, s[12:15], s45 offen sc1
    s_barrier
    s_barrier
    s_barrier
    s_barrier
    s_barrier
    v_lshlrev_b32 v55, 2, v0
    s_mov_b32 s59, 4
    s_sub_u32 s7, s53, 27
    s_cmp_lt_u32 s7, 4
    s_cbranch_scc0 L_X_w8n
    s_lshl_b32 s96, s59, 1
    v_lshrrev_b32 v8, 2, v3
    v_lshl_add_u32 v9, v2, 3, v8
    v_mul_u32_u24 v9, 1152, v9
    v_lshl_add_u32 v9, s96, 7, v9
    v_and_b32 v56, 3, v0
    v_lshl_add_u32 v9, v56, 3, v9
    v_lshrrev_b32 v8, 1, v8
    v_and_b32 v56, 1, v2
    v_lshl_add_u32 v8, v56, 1, v8
    v_lshl_add_u32 v56, v8, 5, v9
    v_xor_b32 v57, 32, v56
    v_xor_b32 v58, 64, v56
    v_xor_b32 v59, 0x60, v56
    ds_read_b64_tr_b16 v[80:81], v56 offset:0
    ds_read_b64_tr_b16 v[82:83], v56 offset:4608
    ds_read_b64_tr_b16 v[84:85], v57 offset:0
    ds_read_b64_tr_b16 v[86:87], v57 offset:4608
    ds_read_b64_tr_b16 v[88:89], v58 offset:0
    ds_read_b64_tr_b16 v[90:91], v58 offset:4608
    ds_read_b64_tr_b16 v[92:93], v59 offset:0
    ds_read_b64_tr_b16 v[94:95], v59 offset:4608
    v_lshlrev_b32 v63, 2, v3
    s_lshl_b32 s7, s51, 6
    s_lshl_b32 s45, s51, 10
    s_add_u32 s45, s45, 393216
    buffer_load_dword v28, v63, s[8:11], s7 offen
    s_mov_b32 s97, s45
    v_and_b32 v8, 1, v0
    v_lshlrev_b32 v8, 6, v8
    v_lshl_add_u32 v8, v2, 4, v8
    v_add_u32 v61, 131840, v8
    v_and_b32 v8, 1, v2
    v_lshl_add_u32 v8, v3, 1, v8
    v_lshrrev_b32 v9, 1, v2
    v_mul_u32_u24 v9, 64, v9
    v_lshl_add_u32 v8, v8, 1, v9
    v_add_u32 v60, 131840, v8
    v_lshl_add_u32 v60, s59, 7, v60
    v_lshl_add_u32 v61, s59, 7, v61
    s_mul_i32 s47, s51, 2432
    s_lshl_b32 s58, s59, 9
    s_add_u32 s47, s47, s58
    s_add_u32 s47, s47, 1048576
    s_mov_b32 s98, 0xffff0000
    s_mov_b32 s99, 0xffff0000
    s_mov_b32 s48, 0
    s_mov_b32 s49, -1
L_X_w8n:
    s_setprio 3
    buffer_load_dwordx3 v[16:18], v62, s[12:15], s46 offen sc1
    s_waitcnt vmcnt(0)
    v_cmp_ne_u32 vcc, s41, v18
    s_nop 1
    s_cbranch_vccz L_X_mlok
    s_lshr_b32 s7, s2, 3
    s_mul_i32 s7, s7, 5
    s_and_b32 s7, s7, 7
    s_mov_b32 exec_lo, 0x1010101
    s_mov_b32 exec_hi, 0x1010101
    s_lshl_b64 exec, exec, s7
L_ml0_5:
    buffer_load_dword v18, v62, s[12:15], s46 offen offset:8 sc1
    s_sub_u32 s42, s42, 1
    s_cbranch_scc1 L_END
    s_waitcnt vmcnt(0)
    v_cmp_ne_u32 vcc, s41, v18
    s_nop 1
    s_cbranch_vccnz L_ml0_5
    s_mov_b64 exec, -1
L_ml_6:
    buffer_load_dwordx3 v[16:18], v62, s[12:15], s46 offen sc1
    s_sub_u32 s42, s42, 1
    s_cbranch_scc1 L_END
    s_waitcnt vmcnt(0)
    v_cmp_ne_u32 vcc, s41, v18
    s_nop 1
    s_and_b64 exec, exec, vcc
    s_cbranch_scc1 L_ml_6
L_X_mlok:
    s_barrier
    s_mov_b64 exec, -1
    v_max_f32_dpp v20, v16, v16 row_ror:1 row_mask:0xf bank_mask:0xf
    v_lshlrev_b32 v8, 2, v0
    v_add_u32 v8, 132480, v8
    v_max_f32_dpp v20, v20, v20 row_ror:2 row_mask:0xf bank_mask:0xf
    s_nop 1
    v_max_f32_dpp v20, v20, v20 row_ror:4 row_mask:0xf bank_mask:0xf
    s_nop 1
    v_max_f32_dpp v21, v20, v20 row_ror:8 row_mask:0xf bank_mask:0xf
    v_max_f32_dpp v20, v20, v20 row_ror:8 row_mask:0xf bank_mask:0xf
    s_nop 1
    v_permlane16_swap_b32 v20, v21
    v_max_f32 v20, v20, v21
    v_sub_f32 v16, v16, v20
    v_exp_f32 v16, v16
    s_nop 0
    v_mul_f32 v17, v16, v17
    s_nop 1
    v_add_f32_dpp v17, v17, v17 row_ror:1 row_mask:0xf bank_mask:0xf
    s_nop 1
    v_add_f32_dpp v17, v17, v17 row_ror:2 row_mask:0xf bank_mask:0xf
    s_nop 1
    v_add_f32_dpp v17, v17, v17 row_ror:4 row_mask:0xf bank_mask:0xf
    s_nop 1
    v_add_f32_dpp v21, v17, v17 row_ror:8 row_mask:0xf bank_mask:0xf
    v_add_f32_dpp v17, v17, v17 row_ror:8 row_mask:0xf bank_mask:0xf
    s_nop 1
    v_permlane16_swap_b32 v17, v21
    v_add_f32 v17, v17, v21
    v_rcp_f32 v17, v17
    s_nop 0
    v_mul_f32 v16, v16, v17
    v_cvt_pk_bf16_f32 v16, v16, v16
    ds_write_b32 v8, v16
    s_waitcnt lgkmcnt(0)
    s_barrier
    s_setprio 0
    s_sub_u32 s7, s53, 27
    s_cmp_lt_u32 s7, 4
    s_cbranch_scc0 L_X_w8e
    s_waitcnt vmcnt(0)
    v_lshlrev_b32 v16, 16, v28
    v_lshlrev_b32 v17, 16, v28
    v_and_b32 v18, 0xffff0000, v28
    v_and_b32 v19, 0xffff0000, v28
    s_mov_b32 exec_hi, 0xffff
    buffer_load_dwordx4 v[16:19], v1, s[12:15], s97 offen sc1
    s_barrier
    s_branch L_g32_7_in
L_g32_7:
    buffer_load_dwordx4 v[16:19], v1, s[12:15], s97 offen sc1
    s_sub_u32 s42, s42, 1
    s_cbranch_scc1 L_END
L_g32_7_in:
    s_waitcnt vmcnt(0)
L_g32_7_chk:
    v_xor_b32 v16, s40, v16
    v_xor_b32 v17, s40, v17
    v_xor_b32 v18, s40, v18
    v_xor_b32 v19, s40, v19
    v_or3_b32 v8, v16, v17, v18
    v_or_b32 v8, v8, v19
    v_and_b32 v8, 0xfff, v8
    v_cmp_ne_u32 vcc, 0, v8
    s_nop 1
    s_cbranch_vccnz L_g32_7
    s_mov_b32 exec_hi, -1
    v_permlane32_swap_b32 v16, v17
    v_permlane32_swap_b32 v18, v19
    v_add_f32 v16, v16, v17
    v_add_f32 v18, v18, v19
    s_nop 1
    v_permlane16_swap_b32 v16, v18
    v_add_f32 v16, v16, v18
    v_max_f32 v16, 0, v16
    v_mul_f32 v16, v16, v16
    v_cvt_pk_bf16_f32 v16, v16, v16
    ds_write_b16 v60, v16 offset:0
    ds_read_b128 v[20:23], v61
    s_waitcnt lgkmcnt(0)
    v_mfma_f32_16x16x32_bf16 v[112:115], v[20:23], v[80:83], 0
    v_mfma_f32_16x16x32_bf16 v[116:119], v[20:23], v[84:87], 0
    v_mfma_f32_16x16x32_bf16 v[120:123], v[20:23], v[88:91], 0
    v_mfma_f32_16x16x32_bf16 v[124:127], v[20:23], v[92:95], 0
    s_nop 7
    v_cndmask_b32 v112, v112, v116, s[98:99]
    v_cndmask_b32 v113, v113, v117, s[98:99]
    v_cndmask_b32 v120, v120, v124, s[98:99]
    v_cndmask_b32 v121, v121, v125, s[98:99]
    v_cndmask_b32 v112, v112, v120, s[48:49]
    v_cndmask_b32 v113, v113, v121, s[48:49]
    v_add_u32 v112, 0x8000, v112
    v_add_u32 v113, 0x8000, v113
    v_cvt_pk_bf16_f32 v112, v112, v113
    v_bfi_b32 v112, s57, v112, v6
    buffer_store_dword v112, v55, s[12:15], s47 offen offset:0 sc1
    s_branch L_END
L_X_w8e:
    s_barrier
L_X_post:
    s_cmp_lt_u32 s53, 16
    s_cbranch_scc0 L_END
L_X_final:
    s_lshr_b32 s7, s2, 5
    s_and_b32 s45, s2, 7
    s_lshl3_add_u32 s7, s7, s45
    s_lshl1_add_u32 s4, s7, s6
    s_cmp_lt_u32 s4, 36
    s_cbranch_scc0 L_END
    v_lshrrev_b32 v8, 2, v0
    v_mul_u32_u24 v8, 2432, v8
    v_and_b32 v9, 3, v0
    v_lshl_add_u32 v10, v9, 4, v8
    s_mul_i32 s7, s3, 38912
    s_lshl_b32 s45, s4, 6
    s_add_u32 s7, s7, s45
    s_add_u32 s7, s7, 1048576
    s_lshl_b32 s58, s4, 5
    v_lshlrev_b32 v55, 1, v3
    v_and_b32 v8, 1, v2
    v_mul_u32_u24 v56, 1152, v8
    v_add_u32 v56, v56, v55
    v_lshrrev_b32 v59, 1, v2
    v_lshl_add_u32 v8, v8, 1, v59
    v_lshl_add_u32 v8, v9, 2, v8
    v_mul_u32_u24 v8, 48, v8
    v_lshl_add_u32 v8, s3, 2, v8
    v_and_b32 v11, 31, v0
    v_mul_u32_u24 v11, 48, v11
    v_add_u32 v61, 130304, v11
    v_lshl_add_u32 v60, v59, 4, v61
    v_add_u32 v59, 130304, v8
    s_cmp_eq_u32 s3, 8
    s_cbranch_scc0 L_X_nxb
    buffer_load_ushort v57, v56, s[16:19], s58 offen
    buffer_load_ushort v58, v55, s[32:35], s58 offen
L_X_nxb:
L_h4_8:
    buffer_load_dwordx4 v[16:19], v10, s[12:15], s7 offen sc1
    s_sub_u32 s42, s42, 1
    s_cbranch_scc1 L_END
    s_waitcnt vmcnt(0)
    v_xor_b32 v16, s56, v16
    v_xor_b32 v17, s56, v17
    v_xor_b32 v18, s56, v18
    v_xor_b32 v19, s56, v19
    v_or3_b32 v8, v16, v17, v18
    v_or_b32 v8, v8, v19
    v_and_b32 v8, 0x10001, v8
    v_cmp_ne_u32 vcc, 0, v8
    v_permlane32_swap_b32 v16, v17
    v_permlane32_swap_b32 v18, v19
    s_cbranch_vccnz L_h4_8
    v_lshlrev_b32 v20, 16, v16
    v_and_b32 v21, 0xffff0000, v16
    v_lshlrev_b32 v22, 16, v17
    v_and_b32 v23, 0xffff0000, v17
    v_lshlrev_b32 v24, 16, v18
    v_and_b32 v25, 0xffff0000, v18
    v_lshlrev_b32 v26, 16, v19
    v_and_b32 v27, 0xffff0000, v19
    v_pk_add_f32 v[20:21], v[20:21], v[22:23]
    v_pk_add_f32 v[24:25], v[24:25], v[26:27]
    v_lshlrev_b32 v57, 16, v57
    v_lshlrev_b32 v58, 16, v58
    v_permlane16_swap_b32 v20, v24
    v_permlane16_swap_b32 v21, v25
    v_pk_add_f32 v[20:21], v[20:21], v[24:25]
    v_add_f32 v57, v57, v58
    s_cmp_eq_u32 s3, 8
    v_add_f32_dpp v20, v20, v20 row_ror:8 row_mask:0xf bank_mask:0xf
    v_add_f32_dpp v21, v21, v21 row_ror:8 row_mask:0xf bank_mask:0xf
    s_nop 0
    v_add_f32_dpp v20, v20, v20 row_ror:4 row_mask:0xf bank_mask:0xf
    v_add_f32_dpp v21, v21, v21 row_ror:4 row_mask:0xf bank_mask:0xf
    ds_write2_b32 v59, v20, v21 offset0:0 offset1:192
    s_waitcnt lgkmcnt(0)
    s_barrier
    s_cbranch_scc0 L_END
    ds_read_b128 v[16:19], v60
    ds_read_b32 v20, v61 offset:32
    s_waitcnt lgkmcnt(1)
    v_pk_add_f32 v[16:17], v[16:17], v[18:19]
    v_add_f32 v18, v16, v17
    v_add_f32 v16, v16, v17
    s_waitcnt lgkmcnt(0)
    v_add_f32 v57, v57, v20
    v_permlane32_swap_b32 v16, v18
    v_add_f32 v16, v16, v18
    v_add_f32 v16, v16, v57
    v_cvt_pk_bf16_f32 v16, v16, v16
    s_mov_b32 exec_hi, 0
    buffer_store_short v16, v56, s[36:39], s58 offen
    s_cmp_eq_u32 s2, 0
    s_cbranch_scc0 L_END
    v_mov_b32 v17, s41
    v_mov_b32 v18, 0
    buffer_store_dword v17, v18, s[12:15], 0 offen
    s_branch L_END
L_Y2:
    s_mov_b32 s10, 8388608
    s_sub_u32 s53, s2, 128
    s_bfe_u32 s52, s2, 0x10003
    s_and_b32 s7, s2, 7
    s_lshr_b32 s45, s53, 4
    s_lshl3_add_u32 s51, s7, s45
    s_lshl1_add_u32 s44, s51, s52
    s_lshl2_add_u32 s44, s44, s3
    s_lshl_b32 s44, s44, 14
    s_mul_i32 m0, s3, 16896
    s_cmp_lt_u32 s3, 4
    s_waitcnt lgkmcnt(0)
    s_load_dword s41, s[12:13], 0
    s_cmp_eq_u32 s3, 5
    s_cbranch_scc0 L_Y_nh1
    s_lshr_b32 s45, s53, 3
    s_lshl4_add_u32 s7, s7, s45
    s_lshl_b32 s7, s7, 10
    s_add_u32 s7, s7, 65536
    buffer_load_dwordx4 v[16:19], v1, s[12:15], s7 offen sc1
L_Y_nh1:
    s_cmp_lt_u32 s3, 4
    s_barrier
    s_cbranch_scc0 L_Y_noc
    buffer_load_dwordx4 v1, s[8:11], s44 offen offset:0  lds
    s_addk_i32 m0, 32
    s_nop 0
    buffer_load_dwordx4 v1, s[8:11], s44 offen offset:1024  lds
    s_addk_i32 m0, 32
    s_nop 0
    buffer_load_dwordx4 v1, s[8:11], s44 offen offset:2048  lds
    s_addk_i32 m0, 32
    s_nop 0
    buffer_load_dwordx4 v1, s[8:11], s44 offen offset:3072  lds
    s_add_u32 m0, m0, 4128
    s_addk_i32 s44, 4096
    buffer_load_dwordx4 v1, s[8:11], s44 offen offset:0  lds
    s_addk_i32 m0, 32
    s_nop 0
    buffer_load_dwordx4 v1, s[8:11], s44 offen offset:1024  lds
    s_addk_i32 m0, 32
    s_nop 0
    buffer_load_dwordx4 v1, s[8:11], s44 offen offset:2048  lds
    s_addk_i32 m0, 32
    s_nop 0
    buffer_load_dwordx4 v1, s[8:11], s44 offen offset:3072  lds
    s_add_u32 m0, m0, 4128
    s_addk_i32 s44, 4096
L_Y_noc:
    s_load_dwordx2 s[60:61], s[0:1], 40
    s_load_dwordx2 s[24:25], s[0:1], 64
    s_load_dwordx2 s[28:29], s[0:1], 72
    s_mov_b32 s62, 4718592
    s_mov_b32 s63, s11
    s_mov_b32 s26, 9216
    s_mov_b32 s27, s11
    s_mov_b32 s30, 5308416
    s_mov_b32 s31, s11
    s_lshr_b32 s50, s51, 5
    s_and_b32 s7, s2, 7
    s_lshr_b32 s45, s53, 3
    s_lshl4_add_u32 s4, s7, s45
    s_lshr_b32 s46, s45, 2
    s_add_u32 s47, s7, s46
    s_and_b32 s47, s47, 7
    s_lshl3_add_u32 s100, s46, s47
    s_and_b32 s45, s45, 3
    s_lshl2_add_u32 s100, s100, s45
    s_lshl2_add_u32 s5, s7, s45
    s_mov_b32 s42, 0xfffff
    s_mov_b32 s43, 0xfffff000
    s_mov_b32 s57, 0xfffefffe
    s_waitcnt lgkmcnt(0)
    s_add_u32 s41, s41, 1
    s_and_b32 s40, s41, 0xfff
    s_andn2_b32 s56, s41, s57
    v_mov_b32 v6, s41
    s_cmp_eq_u32 s3, 8
    s_cbranch_scc1 L_Y_w8
    s_cmp_lt_u32 s3, 4
    s_cbranch_scc0 L_Y_nqk
    buffer_load_dwordx4 v1, s[8:11], s44 offen offset:0  lds
    s_addk_i32 m0, 32
    s_nop 0
    buffer_load_dwordx4 v1, s[8:11], s44 offen offset:1024  lds
    s_addk_i32 m0, 32
    s_nop 0
    buffer_load_dwordx4 v1, s[8:11], s44 offen offset:2048  lds
    s_addk_i32 m0, 32
    s_nop 0
    buffer_load_dwordx4 v1, s[8:11], s44 offen offset:3072  lds
    s_add_u32 m0, m0, 4128
    s_addk_i32 s44, 4096
    buffer_load_dwordx4 v1, s[8:11], s44 offen offset:0  lds
    s_addk_i32 m0, 32
    s_nop 0
    buffer_load_dwordx4 v1, s[8:11], s44 offen offset:1024  lds
    s_addk_i32 m0, 32
    s_nop 0
    buffer_load_dwordx4 v1, s[8:11], s44 offen offset:2048  lds
    s_addk_i32 m0, 32
    s_nop 0
    buffer_load_dwordx4 v1, s[8:11], s44 offen offset:3072  lds
    s_add_u32 m0, m0, 54816
    s_xor_b32 s44, s44, 114688
    s_barrier
    v_mul_u32_u24 v8, 1056, v3
    v_lshl_add_u32 v8, v2, 4, v8
    s_mul_i32 s7, s3, 16896
    v_add_u32 v4, s7, v8
    v_add_u32 v7, 67584, v4
    v_add_u32 v5, 135168, v8
    v_lshlrev_b32 v13, 4, v3
    v_add_u32 v11, 156160, v13
    v_lshl_add_u32 v10, s3, 2, v11
    s_lshl_b32 s7, s3, 10
    s_add_u32 s7, s7, 152064
    v_add_u32 v12, s7, v1
    s_mov_b32 s45, 0x3e0293ee
    buffer_load_dwordx4 v1, s[8:11], s44 offen offset:0  lds
    s_addk_i32 m0, 32
    s_nop 0
    buffer_load_dwordx4 v1, s[8:11], s44 offen offset:1024  lds
    s_addk_i32 m0, 32
    s_nop 0
    buffer_load_dwordx4 v1, s[8:11], s44 offen offset:2048  lds
    s_addk_i32 m0, 32
    s_nop 0
    buffer_load_dwordx4 v1, s[8:11], s44 offen offset:3072  lds
    s_add_u32 m0, m0, 4128
    s_addk_i32 s44, -4096
    buffer_load_dwordx4 v1, s[8:11], s44 offen offset:0  lds
    s_addk_i32 m0, 32
    s_nop 0
    buffer_load_dwordx4 v1, s[8:11], s44 offen offset:1024  lds
    s_addk_i32 m0, 32
    s_nop 0
    buffer_load_dwordx4 v1, s[8:11], s44 offen offset:2048  lds
    s_addk_i32 m0, 32
    s_nop 0
    buffer_load_dwordx4 v1, s[8:11], s44 offen offset:3072  lds
    s_add_u32 m0, m0, 4128
    s_addk_i32 s44, -4096
    buffer_load_dwordx4 v1, s[8:11], s44 offen offset:0  lds
    s_addk_i32 m0, 32
    s_nop 0
    buffer_load_dwordx4 v1, s[8:11], s44 offen offset:1024  lds
    s_addk_i32 m0, 32
    s_nop 0
    buffer_load_dwordx4 v1, s[8:11], s44 offen offset:2048  lds
    s_addk_i32 m0, 32
    s_nop 0
    buffer_load_dwordx4 v1, s[8:11], s44 offen offset:3072  lds
    s_add_u32 m0, m0, 4128
    s_addk_i32 s44, -4096
    buffer_load_dwordx4 v1, s[8:11], s44 offen offset:0  lds
    s_addk_i32 m0, 32
    s_nop 0
    buffer_load_dwordx4 v1, s[8:11], s44 offen offset:1024  lds
    s_addk_i32 m0, 32
    s_nop 0
    buffer_load_dwordx4 v1, s[8:11], s44 offen offset:2048  lds
    s_addk_i32 m0, 32
    s_nop 0
    buffer_load_dwordx4 v1, s[8:11], s44 offen offset:3072  lds
    s_waitcnt vmcnt(16)
    s_barrier
    ds_read_b128 v[40:43], v4 offset:0
    ds_read_b128 v[48:51], v4 offset:64
    ds_read_b128 v[56:59], v4 offset:128
    ds_read_b128 v[64:67], v4 offset:192
    ds_read_b128 v[72:75], v4 offset:256
    ds_read_b128 v[80:83], v4 offset:320
    ds_read_b128 v[88:91], v4 offset:384
    ds_read_b128 v[96:99], v4 offset:448
    ds_read_b128 v[104:107], v4 offset:512
    ds_read_b128 v[112:115], v4 offset:576
    ds_read_b128 v[120:123], v4 offset:640
    ds_read_b128 v[128:131], v4 offset:704
    ds_read_b128 v[136:139], v4 offset:768
    ds_read_b128 v[144:147], v4 offset:832
    ds_read_b128 v[152:155], v4 offset:896
    ds_read_b128 v[160:163], v4 offset:960
    s_waitcnt vmcnt(8)
    s_barrier
    s_waitcnt vmcnt(0) lgkmcnt(0)
    ds_read_b128 v[44:47], v7 offset:0
    ds_read_b128 v[52:55], v7 offset:64
    ds_read_b128 v[60:63], v7 offset:128
    ds_read_b128 v[68:71], v7 offset:192
    s_barrier
    ds_read_b128 v[16:19], v5 offset:0
    ds_read_b128 v[20:23], v5 offset:64
    ds_read_b128 v[24:27], v5 offset:128
    ds_read_b128 v[28:31], v5 offset:192
    ds_read_b128 v[76:79], v7 offset:256
    s_waitcnt lgkmcnt(4)
    v_mfma_f32_16x16x32_bf16 v[32:35], v[40:43], v[16:19], 0
    v_mfma_f32_16x16x32_bf16 v[36:39], v[44:47], v[16:19], 0
    ds_read_b128 v[16:19], v5 offset:256
    ds_read_b128 v[84:87], v7 offset:320
    s_waitcnt lgkmcnt(5)
    v_mfma_f32_16x16x32_bf16 v[32:35], v[48:51], v[20:23], v[32:35]
    v_mfma_f32_16x16x32_bf16 v[36:39], v[52:55], v[20:23], v[36:39]
    ds_read_b128 v[20:23], v5 offset:320
    ds_read_b128 v[92:95], v7 offset:384
    s_waitcnt lgkmcnt(6)
    v_mfma_f32_16x16x32_bf16 v[32:35], v[56:59], v[24:27], v[32:35]
    v_mfma_f32_16x16x32_bf16 v[36:39], v[60:63], v[24:27], v[36:39]
    ds_read_b128 v[24:27], v5 offset:384
    ds_read_b128 v[100:103], v7 offset:448
    s_waitcnt lgkmcnt(7)
    v_mfma_f32_16x16x32_bf16 v[32:35], v[64:67], v[28:31], v[32:35]
    v_mfma_f32_16x16x32_bf16 v[36:39], v[68:71], v[28:31], v[36:39]
    ds_read_b128 v[28:31], v5 offset:448
    ds_read_b128 v[108:111], v7 offset:512
    s_waitcnt lgkmcnt(7)
    v_mfma_f32_16x16x32_bf16 v[32:35], v[72:75], v[16:19], v[32:35]
    v_mfma_f32_16x16x32_bf16 v[36:39], v[76:79], v[16:19], v[36:39]
    ds_read_b128 v[16:19], v5 offset:512
    ds_read_b128 v[116:119], v7 offset:576
    s_waitcnt lgkmcnt(7)
    v_mfma_f32_16x16x32_bf16 v[32:35], v[80:83], v[20:23], v[32:35]
    v_mfma_f32_16x16x32_bf16 v[36:39], v[84:87], v[20:23], v[36:39]
    ds_read_b128 v[20:23], v5 offset:576
    ds_read_b128 v[124:127], v7 offset:640
    s_waitcnt lgkmcnt(7)
    v_mfma_f32_16x16x32_bf16 v[32:35], v[88:91], v[24:27], v[32:35]
    v_mfma_f32_16x16x32_bf16 v[36:39], v[92:95], v[24:27], v[36:39]
    ds_read_b128 v[24:27], v5 offset:640
    ds_read_b128 v[132:135], v7 offset:704
    s_waitcnt lgkmcnt(7)
    v_mfma_f32_16x16x32_bf16 v[32:35], v[96:99], v[28:31], v[32:35]
    v_mfma_f32_16x16x32_bf16 v[36:39], v[100:103], v[28:31], v[36:39]
    ds_read_b128 v[28:31], v5 offset:704
    ds_read_b128 v[140:143], v7 offset:768
    s_waitcnt lgkmcnt(7)
    v_mfma_f32_16x16x32_bf16 v[32:35], v[104:107], v[16:19], v[32:35]
    v_mfma_f32_16x16x32_bf16 v[36:39], v[108:111], v[16:19], v[36:39]
    ds_read_b128 v[16:19], v5 offset:768
    ds_read_b128 v[148:151], v7 offset:832
    s_waitcnt lgkmcnt(7)
    v_mfma_f32_16x16x32_bf16 v[32:35], v[112:115], v[20:23], v[32:35]
    v_mfma_f32_16x16x32_bf16 v[36:39], v[116:119], v[20:23], v[36:39]
    ds_read_b128 v[20:23], v5 offset:832
    ds_read_b128 v[156:159], v7 offset:896
    s_waitcnt lgkmcnt(7)
    v_mfma_f32_16x16x32_bf16 v[32:35], v[120:123], v[24:27], v[32:35]
    v_mfma_f32_16x16x32_bf16 v[36:39], v[124:127], v[24:27], v[36:39]
    ds_read_b128 v[24:27], v5 offset:896
    ds_read_b128 v[164:167], v7 offset:960
    s_waitcnt lgkmcnt(7)
    v_mfma_f32_16x16x32_bf16 v[32:35], v[128:131], v[28:31], v[32:35]
    v_mfma_f32_16x16x32_bf16 v[36:39], v[132:135], v[28:31], v[36:39]
    ds_read_b128 v[28:31], v5 offset:960
    s_waitcnt lgkmcnt(6)
    v_mfma_f32_16x16x32_bf16 v[32:35], v[136:139], v[16:19], v[32:35]
    v_mfma_f32_16x16x32_bf16 v[36:39], v[140:143], v[16:19], v[36:39]
    s_waitcnt lgkmcnt(4)
    v_mfma_f32_16x16x32_bf16 v[32:35], v[144:147], v[20:23], v[32:35]
    v_mfma_f32_16x16x32_bf16 v[36:39], v[148:151], v[20:23], v[36:39]
    s_waitcnt lgkmcnt(2)
    v_mfma_f32_16x16x32_bf16 v[32:35], v[152:155], v[24:27], v[32:35]
    v_mfma_f32_16x16x32_bf16 v[36:39], v[156:159], v[24:27], v[36:39]
    s_waitcnt lgkmcnt(0)
    v_mfma_f32_16x16x32_bf16 v[32:35], v[160:163], v[28:31], v[32:35]
    v_mfma_f32_16x16x32_bf16 v[36:39], v[164:167], v[28:31], v[36:39]
    s_nop 6
    v_max3_f32 v8, v32, v33, v34
    v_max3_f32 v8, v8, v35, v36
    v_max3_f32 v8, v8, v37, v38
    v_max_f32 v9, v8, v39
    v_max_f32 v8, v8, v39
    s_nop 1
    v_permlane16_swap_b32 v8, v9
    v_max_f32 v15, v8, v9
    v_max_f32 v8, v8, v9
    s_nop 1
    v_permlane32_swap_b32 v8, v15
    v_max_f32 v8, v8, v15
    ds_write_b32 v10, v8
    s_waitcnt lgkmcnt(0)
    s_barrier
    ds_read_b128 v[16:19], v11
    s_waitcnt lgkmcnt(0)
    v_max3_f32 v8, v16, v17, v18
    v_max_f32 v8, v8, v19
    v_mul_f32 v24, s45, v8
    v_fma_f32 v32, v32, s45, -v24
    v_fma_f32 v33, v33, s45, -v24
    v_fma_f32 v34, v34, s45, -v24
    v_fma_f32 v35, v35, s45, -v24
    v_fma_f32 v36, v36, s45, -v24
    v_fma_f32 v37, v37, s45, -v24
    v_fma_f32 v38, v38, s45, -v24
    v_fma_f32 v39, v39, s45, -v24
    v_exp_f32 v32, v32
    v_exp_f32 v33, v33
    v_exp_f32 v34, v34
    v_exp_f32 v35, v35
    v_exp_f32 v36, v36
    v_exp_f32 v37, v37
    v_exp_f32 v38, v38
    v_exp_f32 v39, v39
    v_cvt_pk_bf16_f32 v16, v32, v33
    v_cvt_pk_bf16_f32 v17, v34, v35
    v_cvt_pk_bf16_f32 v18, v36, v37
    v_cvt_pk_bf16_f32 v19, v38, v39
    ds_write_b128 v12, v[16:19]
    v_pk_add_f32 v[32:33], v[32:33], v[34:35]
    v_pk_add_f32 v[36:37], v[36:37], v[38:39]
    v_pk_add_f32 v[32:33], v[32:33], v[36:37]
    v_add_f32 v8, v32, v33
    v_add_f32 v9, v32, v33
    s_nop 1
    v_permlane16_swap_b32 v8, v9
    v_add_f32 v15, v8, v9
    v_add_f32 v8, v8, v9
    s_nop 1
    v_permlane32_swap_b32 v8, v15
    v_add_f32 v8, v8, v15
    ds_write_b32 v10, v8 offset:256
    s_waitcnt lgkmcnt(0)
    s_barrier
    s_mul_i32 s59, s3, 3
    s_add_u32 s59, s59, 24
    v_lshrrev_b32 v8, 3, v0
    v_lshl_add_u32 v8, s59, 3, v8
    v_mul_u32_u24 v8, 57, v8
    v_bfe_u32 v9, v8, 10, 1
    v_bfe_u32 v40, v8, 12, 1
    v_lshl_add_u32 v9, v40, 1, v9
    v_lshlrev_b32 v9, 5, v9
    v_xor_b32 v40, v9, v1
    v_add_u32 v8, 456, v8
    v_bfe_u32 v9, v8, 10, 1
    v_bfe_u32 v41, v8, 12, 1
    v_lshl_add_u32 v9, v41, 1, v9
    v_lshlrev_b32 v9, 5, v9
    v_xor_b32 v41, v9, v1
    v_add_u32 v8, 456, v8
    v_bfe_u32 v9, v8, 10, 1
    v_bfe_u32 v42, v8, 12, 1
    v_lshl_add_u32 v9, v42, 1, v9
    v_lshlrev_b32 v9, 5, v9
    v_xor_b32 v42, v9, v1
    s_lshl_b32 s58, s59, 10
    s_add_u32 m0, s58, 0
    s_mul_i32 s44, s53, 36864
    s_add_u32 s44, s44, m0
    buffer_load_dwordx4 v40, s[28:31], s44 offen offset:0 nt lds
    buffer_load_dwordx4 v41, s[28:31], s44 offen offset:1024 nt lds
    buffer_load_dwordx4 v42, s[28:31], s44 offen offset:2048 nt lds
    s_add_u32 s59, s59, 3
    s_barrier
    s_branch L_Y_b5
L_Y_nqk:
    s_sub_u32 s59, s3, 4
    s_mul_i32 s59, s59, 6
    v_lshrrev_b32 v8, 3, v0
    v_lshl_add_u32 v8, s59, 3, v8
    v_mul_u32_u24 v8, 57, v8
    v_bfe_u32 v9, v8, 10, 1
    v_bfe_u32 v24, v8, 12, 1
    v_lshl_add_u32 v9, v24, 1, v9
    v_lshlrev_b32 v9, 5, v9
    v_xor_b32 v24, v9, v1
    v_add_u32 v8, 456, v8
    v_bfe_u32 v9, v8, 10, 1
    v_bfe_u32 v25, v8, 12, 1
    v_lshl_add_u32 v9, v25, 1, v9
    v_lshlrev_b32 v9, 5, v9
    v_xor_b32 v25, v9, v1
    v_add_u32 v8, 456, v8
    v_bfe_u32 v9, v8, 10, 1
    v_bfe_u32 v26, v8, 12, 1
    v_lshl_add_u32 v9, v26, 1, v9
    v_lshlrev_b32 v9, 5, v9
    v_xor_b32 v26, v9, v1
    v_add_u32 v8, 456, v8
    v_bfe_u32 v9, v8, 10, 1
    v_bfe_u32 v27, v8, 12, 1
    v_lshl_add_u32 v9, v27, 1, v9
    v_lshlrev_b32 v9, 5, v9
    v_xor_b32 v27, v9, v1
    v_add_u32 v8, 456, v8
    v_bfe_u32 v9, v8, 10, 1
    v_bfe_u32 v28, v8, 12, 1
    v_lshl_add_u32 v9, v28, 1, v9
    v_lshlrev_b32 v9, 5, v9
    v_xor_b32 v28, v9, v1
    v_add_u32 v8, 456, v8
    v_bfe_u32 v9, v8, 10, 1
    v_bfe_u32 v29, v8, 12, 1
    v_lshl_add_u32 v9, v29, 1, v9
    v_lshlrev_b32 v9, 5, v9
    v_xor_b32 v29, v9, v1
    v_lshrrev_b32 v8, 2, v0
    v_mul_u32_u24 v8, 1056, v8
    v_and_b32 v9, 3, v0
    v_lshl_add_u32 v8, v9, 3, v8
    s_lshl_b32 s7, s3, 8
    s_sub_u32 s7, s7, 1024
    v_add_u32 v4, s7, v8
    v_add_u32 v5, 67584, v4
    v_add_u32 v12, 152064, v1
    v_lshlrev_b32 v8, 4, v3
    v_lshl_add_u32 v13, v2, 18, v8
    s_lshl_b32 s7, s52, 20
    s_lshl_b32 s47, s3, 14
    s_add_u32 s7, s7, s47
    s_lshl_b32 s47, s51, 8
    s_add_u32 s7, s7, s47
    s_add_u32 s7, s7, 3080192
    s_add_u32 s45, s7, 0x10000
    s_add_u32 s46, s7, 0x20000
    s_add_u32 s47, s7, 0x30000
    s_lshl2_add_u32 s58, s52, s3
    s_lshl3_add_u32 s101, s50, s58
    s_lshl_b32 s101, s101, 12
    s_add_u32 s101, s101, 180224
    s_mul_i32 s44, s3, 4224
    s_add_u32 s44, s44, 118272
    v_add_u32 v14, s44, v1
    s_barrier
    s_barrier
    s_barrier
    buffer_load_dwordx4 v[16:19], v1, s[12:15], s101 offen offset:0 sc1
    buffer_load_dwordx4 v[20:23], v1, s[12:15], s101 offen offset:1024 sc1
    buffer_load_dwordx4 v[32:35], v1, s[12:15], s101 offen offset:2048 sc1
    buffer_load_dwordx4 v[36:39], v1, s[12:15], s101 offen offset:3072 sc1
    ds_read_b64_tr_b16 v[40:41], v4 offset:0
    ds_read_b64_tr_b16 v[44:45], v4 offset:16896
    ds_read_b64_tr_b16 v[48:49], v4 offset:33792
    ds_read_b64_tr_b16 v[52:53], v4 offset:50688
    ds_read_b64_tr_b16 v[56:57], v4 offset:32
    ds_read_b64_tr_b16 v[60:61], v4 offset:16928
    ds_read_b64_tr_b16 v[64:65], v4 offset:33824
    ds_read_b64_tr_b16 v[68:69], v4 offset:50720
    ds_read_b64_tr_b16 v[72:73], v4 offset:64
    ds_read_b64_tr_b16 v[76:77], v4 offset:16960
    ds_read_b64_tr_b16 v[80:81], v4 offset:33856
    ds_read_b64_tr_b16 v[84:85], v4 offset:50752
    ds_read_b64_tr_b16 v[88:89], v4 offset:96
    ds_read_b64_tr_b16 v[92:93], v4 offset:16992
    ds_read_b64_tr_b16 v[96:97], v4 offset:33888
    ds_read_b64_tr_b16 v[100:101], v4 offset:50784
    ds_read_b64_tr_b16 v[104:105], v4 offset:128
    ds_read_b64_tr_b16 v[108:109], v4 offset:17024
    ds_read_b64_tr_b16 v[112:113], v4 offset:33920
    ds_read_b64_tr_b16 v[116:117], v4 offset:50816
    ds_read_b64_tr_b16 v[120:121], v4 offset:160
    ds_read_b64_tr_b16 v[124:125], v4 offset:17056
    ds_read_b64_tr_b16 v[128:129], v4 offset:33952
    ds_read_b64_tr_b16 v[132:133], v4 offset:50848
    ds_read_b64_tr_b16 v[136:137], v4 offset:192
    ds_read_b64_tr_b16 v[140:141], v4 offset:17088
    ds_read_b64_tr_b16 v[144:145], v4 offset:33984
    ds_read_b64_tr_b16 v[148:149], v4 offset:50880
    ds_read_b64_tr_b16 v[152:153], v4 offset:224
    ds_read_b64_tr_b16 v[156:157], v4 offset:17120
    ds_read_b64_tr_b16 v[160:161], v4 offset:34016
    ds_read_b64_tr_b16 v[164:165], v4 offset:50912
    s_branch L_h2_9_in
L_h2_9:
    buffer_load_dwordx4 v[16:19], v1, s[12:15], s101 offen offset:0 sc1
    buffer_load_dwordx4 v[20:23], v1, s[12:15], s101 offen offset:1024 sc1
    buffer_load_dwordx4 v[32:35], v1, s[12:15], s101 offen offset:2048 sc1
    buffer_load_dwordx4 v[36:39], v1, s[12:15], s101 offen offset:3072 sc1
    s_sub_u32 s42, s42, 1
    s_cbranch_scc1 L_END
L_h2_9_in:
    s_waitcnt vmcnt(3)
    v_xor_b32 v16, s56, v16
    v_xor_b32 v17, s56, v17
    v_xor_b32 v18, s56, v18
    v_xor_b32 v19, s56, v19
    ds_write_b128 v14, v[16:19] offset:0
    v_or3_b32 v8, v16, v17, v18
    v_or_b32 v8, v8, v19
    s_waitcnt vmcnt(2)
    v_xor_b32 v20, s56, v20
    v_xor_b32 v21, s56, v21
    v_xor_b32 v22, s56, v22
    v_xor_b32 v23, s56, v23
    ds_write_b128 v14, v[20:23] offset:1056
    v_or3_b32 v8, v8, v20, v21
    v_or3_b32 v8, v8, v22, v23
    s_waitcnt vmcnt(1)
    v_xor_b32 v32, s56, v32
    v_xor_b32 v33, s56, v33
    v_xor_b32 v34, s56, v34
    v_xor_b32 v35, s56, v35
    ds_write_b128 v14, v[32:35] offset:2112
    v_or3_b32 v8, v8, v32, v33
    v_or3_b32 v8, v8, v34, v35
    s_waitcnt vmcnt(0)
    v_xor_b32 v36, s56, v36
    v_xor_b32 v37, s56, v37
    v_xor_b32 v38, s56, v38
    v_xor_b32 v39, s56, v39
    ds_write_b128 v14, v[36:39] offset:3168
    v_or3_b32 v8, v8, v36, v37
    v_or3_b32 v8, v8, v38, v39
L_h2_9_chk:
    v_and_b32 v8, 0x10001, v8
    v_cmp_ne_u32 vcc, 0, v8
    s_waitcnt lgkmcnt(0)
    s_nop 0
    s_cbranch_vccnz L_h2_9
    s_barrier
    s_lshl_b32 s58, s59, 10
    s_add_u32 m0, s58, 0
    s_mul_i32 s44, s53, 36864
    s_add_u32 s44, s44, m0
    buffer_load_dwordx4 v24, s[28:31], s44 offen offset:0 nt lds
    buffer_load_dwordx4 v25, s[28:31], s44 offen offset:1024 nt lds
    buffer_load_dwordx4 v26, s[28:31], s44 offen offset:2048 nt lds
    buffer_load_dwordx4 v27, s[28:31], s44 offen offset:3072 nt lds
    s_lshl_b32 s58, s59, 10
    s_add_u32 m0, s58, 4096
    s_mul_i32 s44, s53, 36864
    s_add_u32 s44, s44, m0
    buffer_load_dwordx4 v28, s[28:31], s44 offen offset:0 nt lds
    buffer_load_dwordx4 v29, s[28:31], s44 offen offset:1024 nt lds
    ds_read_b64_tr_b16 v[42:43], v5 offset:0
    ds_read_b64_tr_b16 v[46:47], v5 offset:16896
    ds_read_b64_tr_b16 v[50:51], v5 offset:33792
    ds_read_b64_tr_b16 v[54:55], v5 offset:50688
    ds_read_b64_tr_b16 v[58:59], v5 offset:32
    ds_read_b64_tr_b16 v[62:63], v5 offset:16928
    ds_read_b64_tr_b16 v[66:67], v5 offset:33824
    ds_read_b64_tr_b16 v[70:71], v5 offset:50720
    s_barrier
    ds_read_b64_tr_b16 v[74:75], v5 offset:64
    ds_read_b64_tr_b16 v[78:79], v5 offset:16960
    ds_read_b64_tr_b16 v[82:83], v5 offset:33856
    ds_read_b64_tr_b16 v[86:87], v5 offset:50752
    ds_read_b64_tr_b16 v[90:91], v5 offset:96
    ds_read_b64_tr_b16 v[94:95], v5 offset:16992
    ds_read_b64_tr_b16 v[98:99], v5 offset:33888
    ds_read_b64_tr_b16 v[102:103], v5 offset:50784
    ds_read_b64_tr_b16 v[106:107], v5 offset:128
    ds_read_b64_tr_b16 v[110:111], v5 offset:17024
    ds_read_b64_tr_b16 v[114:115], v5 offset:33920
    ds_read_b64_tr_b16 v[118:119], v5 offset:50816
    ds_read_b64_tr_b16 v[122:123], v5 offset:160
    ds_read_b64_tr_b16 v[126:127], v5 offset:17056
    ds_read_b64_tr_b16 v[130:131], v5 offset:33952
    ds_read_b64_tr_b16 v[134:135], v5 offset:50848
    ds_read_b64_tr_b16 v[138:139], v5 offset:192
    ds_read_b64_tr_b16 v[142:143], v5 offset:17088
    ds_read_b64_tr_b16 v[146:147], v5 offset:33984
    ds_read_b64_tr_b16 v[150:151], v5 offset:50880
    ds_read_b64_tr_b16 v[154:155], v5 offset:224
    ds_read_b64_tr_b16 v[158:159], v5 offset:17120
    ds_read_b64_tr_b16 v[162:163], v5 offset:34016
    ds_read_b64_tr_b16 v[166:167], v5 offset:50912
    s_waitcnt lgkmcnt(0)
    s_setprio 2
    s_barrier
    ds_read_b128 v[16:19], v12 offset:0
    ds_read_b128 v[20:23], v12 offset:1024
    ds_read_b128 v[24:27], v12 offset:2048
    ds_read_b128 v[28:31], v12 offset:3072
    s_waitcnt lgkmcnt(3)
    v_mfma_f32_16x16x32_bf16 v[32:35], v[16:19], v[40:43], 0
    v_mfma_f32_16x16x32_bf16 v[36:39], v[16:19], v[56:59], 0
    s_waitcnt lgkmcnt(2)
    v_mfma_f32_16x16x32_bf16 v[32:35], v[20:23], v[44:47], v[32:35]
    v_mfma_f32_16x16x32_bf16 v[36:39], v[20:23], v[60:63], v[36:39]
    s_waitcnt lgkmcnt(1)
    v_mfma_f32_16x16x32_bf16 v[32:35], v[24:27], v[48:51], v[32:35]
    v_mfma_f32_16x16x32_bf16 v[36:39], v[24:27], v[64:67], v[36:39]
    s_waitcnt lgkmcnt(0)
    v_mfma_f32_16x16x32_bf16 v[32:35], v[28:31], v[52:55], v[32:35]
    v_mfma_f32_16x16x32_bf16 v[36:39], v[28:31], v[68:71], v[36:39]
    v_mfma_f32_16x16x32_bf16 v[40:43], v[16:19], v[72:75], 0
    v_mfma_f32_16x16x32_bf16 v[44:47], v[16:19], v[88:91], 0
    v_mfma_f32_16x16x32_bf16 v[40:43], v[20:23], v[76:79], v[40:43]
    v_mfma_f32_16x16x32_bf16 v[44:47], v[20:23], v[92:95], v[44:47]
    v_mfma_f32_16x16x32_bf16 v[40:43], v[24:27], v[80:83], v[40:43]
    v_mfma_f32_16x16x32_bf16 v[44:47], v[24:27], v[96:99], v[44:47]
    v_mfma_f32_16x16x32_bf16 v[40:43], v[28:31], v[84:87], v[40:43]
    v_mfma_f32_16x16x32_bf16 v[44:47], v[28:31], v[100:103], v[44:47]
    v_mfma_f32_16x16x32_bf16 v[72:75], v[16:19], v[104:107], 0
    v_cvt_pk_bf16_f32 v56, v32, v36
    v_mfma_f32_16x16x32_bf16 v[76:79], v[16:19], v[120:123], 0
    v_cvt_pk_bf16_f32 v60, v33, v37
    v_mfma_f32_16x16x32_bf16 v[72:75], v[20:23], v[108:111], v[72:75]
    v_cvt_pk_bf16_f32 v64, v34, v38
    v_mfma_f32_16x16x32_bf16 v[76:79], v[20:23], v[124:127], v[76:79]
    v_cvt_pk_bf16_f32 v68, v35, v39
    v_mfma_f32_16x16x32_bf16 v[72:75], v[24:27], v[112:115], v[72:75]
    v_bfi_b32 v56, s57, v56, v6
    v_mfma_f32_16x16x32_bf16 v[76:79], v[24:27], v[128:131], v[76:79]
    v_bfi_b32 v60, s57, v60, v6
    v_mfma_f32_16x16x32_bf16 v[72:75], v[28:31], v[116:119], v[72:75]
    v_bfi_b32 v64, s57, v64, v6
    v_mfma_f32_16x16x32_bf16 v[76:79], v[28:31], v[132:135], v[76:79]
    v_bfi_b32 v68, s57, v68, v6
    v_mfma_f32_16x16x32_bf16 v[104:107], v[16:19], v[136:139], 0
    v_cvt_pk_bf16_f32 v57, v40, v44
    v_mfma_f32_16x16x32_bf16 v[108:111], v[16:19], v[152:155], 0
    v_cvt_pk_bf16_f32 v61, v41, v45
    v_mfma_f32_16x16x32_bf16 v[104:107], v[20:23], v[140:143], v[104:107]
    v_cvt_pk_bf16_f32 v65, v42, v46
    v_mfma_f32_16x16x32_bf16 v[108:111], v[20:23], v[156:159], v[108:111]
    v_cvt_pk_bf16_f32 v69, v43, v47
    v_mfma_f32_16x16x32_bf16 v[104:107], v[24:27], v[144:147], v[104:107]
    v_bfi_b32 v57, s57, v57, v6
    v_mfma_f32_16x16x32_bf16 v[108:111], v[24:27], v[160:163], v[108:111]
    v_bfi_b32 v61, s57, v61, v6
    v_mfma_f32_16x16x32_bf16 v[104:107], v[28:31], v[148:151], v[104:107]
    v_bfi_b32 v65, s57, v65, v6
    v_mfma_f32_16x16x32_bf16 v[108:111], v[28:31], v[164:167], v[108:111]
    v_bfi_b32 v69, s57, v69, v6
    v_cvt_pk_bf16_f32 v58, v72, v76
    v_cvt_pk_bf16_f32 v62, v73, v77
    v_cvt_pk_bf16_f32 v66, v74, v78
    v_cvt_pk_bf16_f32 v70, v75, v79
    v_bfi_b32 v58, s57, v58, v6
    v_bfi_b32 v62, s57, v62, v6
    v_bfi_b32 v66, s57, v66, v6
    v_bfi_b32 v70, s57, v70, v6
    v_cvt_pk_bf16_f32 v59, v104, v108
    v_bfi_b32 v59, s57, v59, v6
    buffer_store_dwordx4 v[56:59], v13, s[12:15], s7 offen sc1
    v_cvt_pk_bf16_f32 v63, v105, v109
    v_bfi_b32 v63, s57, v63, v6
    buffer_store_dwordx4 v[60:63], v13, s[12:15], s45 offen sc1
    v_cvt_pk_bf16_f32 v67, v106, v110
    v_bfi_b32 v67, s57, v67, v6
    buffer_store_dwordx4 v[64:67], v13, s[12:15], s46 offen sc1
    v_cvt_pk_bf16_f32 v71, v107, v111
    v_bfi_b32 v71, s57, v71, v6
    buffer_store_dwordx4 v[68:71], v13, s[12:15], s47 offen sc1
    s_setprio 0
    s_waitcnt vmcnt(4)
    s_barrier
    s_branch L_Y_b5
L_Y_w8:
    v_add_u32 v11, 156160, v1
    s_lshl_b32 s7, s52, 6
    s_add_u32 s7, s7, s51
    s_lshl_b32 s7, s7, 9
    s_add_u32 s7, s7, 589824
    s_and_b32 s45, s51, 12
    v_add_u32 v8, s45, v0
    v_bfe_u32 v8, v8, 2, 2
    v_and_b32 v9, 3, v0
    v_lshlrev_b32 v9, 4, v9
    v_lshl_add_u32 v13, v8, 7, v9
    s_mov_b32 s45, 0x3e0293ee
    v_mov_b32 v22, v6
    v_mov_b32 v23, v6
    v_lshlrev_b32 v7, 7, v0
    s_lshl_b32 s47, s52, 13
    s_add_u32 s47, s47, 655360
    s_setprio 3
    s_barrier
    s_barrier
    s_barrier
    s_barrier
    s_mov_b64 exec, 0xffff
    s_barrier
    ds_read_b128 v[16:19], v11
    s_waitcnt lgkmcnt(0)
    v_max3_f32 v8, v16, v17, v18
    v_max_f32 v8, v8, v19
    v_mul_f32 v20, s45, v8
    s_barrier
    ds_read_b128 v[16:19], v11 offset:256
    s_waitcnt lgkmcnt(0)
    v_add_f32 v16, v16, v17
    v_add_f32 v18, v18, v19
    v_add_f32 v21, v16, v18
    buffer_store_dwordx4 v[20:23], v13, s[12:15], s7 offen sc1
    s_mov_b64 exec, -1
    s_setprio 0
    s_barrier
L_Y_b5:
    s_cmp_eq_u32 s3, 7
    s_cbranch_scc0 L_Y_nh
    v_lshlrev_b32 v63, 2, v3
    s_lshl_b32 s7, s53, 6
    s_lshl_b32 s45, s53, 10
    s_add_u32 s45, s45, 393216
    buffer_load_dword v28, v63, s[24:27], s7 offen
    s_mov_b32 exec_hi, 0xffff
    buffer_load_dwordx4 v[16:19], v1, s[12:15], s45 offen sc1
    s_mov_b32 exec_hi, -1
L_Y_nh:
    s_lshl_b32 s7, s3, 2
    v_lshrrev_b32 v8, 3, v0
    v_lshl_add_u32 v8, s7, 3, v8
    v_mul_u32_u24 v8, 57, v8
    v_bfe_u32 v9, v8, 10, 1
    v_bfe_u32 v24, v8, 12, 1
    v_lshl_add_u32 v9, v24, 1, v9
    v_lshlrev_b32 v9, 5, v9
    v_xor_b32 v24, v9, v1
    v_add_u32 v8, 456, v8
    v_bfe_u32 v9, v8, 10, 1
    v_bfe_u32 v25, v8, 12, 1
    v_lshl_add_u32 v9, v25, 1, v9
    v_lshlrev_b32 v9, 5, v9
    v_xor_b32 v25, v9, v1
    v_add_u32 v8, 456, v8
    v_bfe_u32 v9, v8, 10, 1
    v_bfe_u32 v26, v8, 12, 1
    v_lshl_add_u32 v9, v26, 1, v9
    v_lshlrev_b32 v9, 5, v9
    v_xor_b32 v26, v9, v1
    v_add_u32 v8, 456, v8
    v_bfe_u32 v9, v8, 10, 1
    v_bfe_u32 v27, v8, 12, 1
    v_lshl_add_u32 v9, v27, 1, v9
    v_lshlrev_b32 v9, 5, v9
    v_xor_b32 v27, v9, v1
    s_lshl_b32 s7, s3, 12
    s_add_u32 m0, s7, 36864
    s_mul_i32 s44, s100, 36864
    s_add_u32 s44, s44, s7
    buffer_load_dwordx4 v24, s[60:63], s44 offen offset:0 nt lds
    buffer_load_dwordx4 v25, s[60:63], s44 offen offset:1024 nt lds
    buffer_load_dwordx4 v26, s[60:63], s44 offen offset:2048 nt lds
    buffer_load_dwordx4 v27, s[60:63], s44 offen offset:3072 nt lds
L_Y_b5b:
    v_lshrrev_b32 v8, 2, v3
    v_lshl_add_u32 v9, v2, 3, v8
    v_mul_u32_u24 v9, 1152, v9
    v_lshl_add_u32 v9, s3, 7, v9
    v_and_b32 v56, 3, v0
    v_lshl_add_u32 v9, v56, 3, v9
    v_lshrrev_b32 v8, 1, v8
    v_and_b32 v56, 1, v2
    v_lshl_add_u32 v8, v56, 1, v8
    v_lshl_add_u32 v56, v8, 5, v9
    v_xor_b32 v57, 32, v56
    v_xor_b32 v58, 64, v56
    v_xor_b32 v59, 0x60, v56
    v_and_b32 v8, 1, v0
    v_lshlrev_b32 v8, 6, v8
    v_lshl_add_u32 v8, v2, 4, v8
    v_add_u32 v61, 156672, v8
    s_mul_i32 s47, s53, 2432
    s_lshl_b32 s58, s3, 8
    s_add_u32 s47, s47, s58
    s_add_u32 s47, s47, 1048576
    v_and_b32 v8, 1, v2
    v_lshl_add_u32 v8, v3, 1, v8
    v_lshrrev_b32 v9, 1, v2
    v_mul_u32_u24 v9, 64, v9
    v_lshl_add_u32 v8, v8, 1, v9
    v_add_u32 v60, 156672, v8
    v_lshlrev_b32 v62, 2, v0
    s_lshl_b32 s46, s4, 10
    s_add_u32 s46, s46, 262144
    s_mov_b32 s98, 0xffff0000
    s_mov_b32 s99, 0xffff0000
    s_mov_b32 s48, 0
    s_mov_b32 s49, -1
    s_cmp_eq_u32 s3, 7
    s_cbranch_scc0 L_Y_nh2
    s_waitcnt vmcnt(4)
    s_mov_b32 exec_lo, 0
    s_mov_b32 exec_hi, 0xffff0000
    v_lshlrev_b32 v16, 16, v28
    v_lshlrev_b32 v17, 16, v28
    v_and_b32 v18, 0xffff0000, v28
    v_and_b32 v19, 0xffff0000, v28
    s_mov_b32 exec_lo, -1
    s_mov_b32 exec_hi, 0xffff
    s_branch L_g32_10_chk
L_g32_10:
    buffer_load_dwordx4 v[16:19], v1, s[12:15], s45 offen sc1
    s_sub_u32 s42, s42, 1
    s_cbranch_scc1 L_END
L_g32_10_in:
    s_waitcnt vmcnt(0)
L_g32_10_chk:
    v_xor_b32 v16, s40, v16
    v_xor_b32 v17, s40, v17
    v_xor_b32 v18, s40, v18
    v_xor_b32 v19, s40, v19
    v_or3_b32 v8, v16, v17, v18
    v_or_b32 v8, v8, v19
    v_and_b32 v8, 0xfff, v8
    v_cmp_ne_u32 vcc, 0, v8
    s_nop 1
    s_cbranch_vccnz L_g32_10
    s_mov_b32 exec_hi, -1
    v_permlane32_swap_b32 v16, v17
    v_permlane32_swap_b32 v18, v19
    v_add_f32 v16, v16, v17
    v_add_f32 v18, v18, v19
    s_nop 1
    v_permlane16_swap_b32 v16, v18
    v_add_f32 v16, v16, v18
    v_max_f32 v16, 0, v16
    v_mul_f32 v16, v16, v16
    v_cvt_pk_bf16_f32 v16, v16, v16
    ds_write_b16 v60, v16 offset:0
L_Y_nh2:
    s_cmp_eq_u32 s3, 8
    s_cbranch_scc1 L_Y_ctx
    s_waitcnt vmcnt(0) lgkmcnt(0)
    s_barrier
    ds_read_b128 v[20:23], v61
    ds_read_b64_tr_b16 v[80:81], v56 offset:0
    ds_read_b64_tr_b16 v[82:83], v56 offset:4608
    ds_read_b64_tr_b16 v[84:85], v57 offset:0
    ds_read_b64_tr_b16 v[86:87], v57 offset:4608
    ds_read_b64_tr_b16 v[88:89], v58 offset:0
    ds_read_b64_tr_b16 v[90:91], v58 offset:4608
    ds_read_b64_tr_b16 v[92:93], v59 offset:0
    ds_read_b64_tr_b16 v[94:95], v59 offset:4608
    ds_read_b64_tr_b16 v[96:97], v56 offset:36864
    ds_read_b64_tr_b16 v[98:99], v56 offset:41472
    ds_read_b64_tr_b16 v[100:101], v57 offset:36864
    ds_read_b64_tr_b16 v[102:103], v57 offset:41472
    ds_read_b64_tr_b16 v[104:105], v58 offset:36864
    ds_read_b64_tr_b16 v[106:107], v58 offset:41472
    ds_read_b64_tr_b16 v[108:109], v59 offset:36864
    ds_read_b64_tr_b16 v[110:111], v59 offset:41472
    s_waitcnt lgkmcnt(8)
    v_mfma_f32_16x16x32_bf16 v[36:39], v[20:23], v[80:83], 0
    v_mfma_f32_16x16x32_bf16 v[40:43], v[20:23], v[84:87], 0
    v_mfma_f32_16x16x32_bf16 v[44:47], v[20:23], v[88:91], 0
    v_mfma_f32_16x16x32_bf16 v[48:51], v[20:23], v[92:95], 0
    s_branch L_Y_c
L_Y_ctx:
    s_setprio 2
    s_waitcnt vmcnt(1)
    s_or_b32 s42, s42, 31
    buffer_load_dwordx4 v[16:19], v1, s[12:15], s46 offen sc1
    s_waitcnt vmcnt(1)
    s_barrier
    ds_read_b128 v[20:23], v61
    ds_read_b64_tr_b16 v[80:81], v56 offset:0
    ds_read_b64_tr_b16 v[82:83], v56 offset:4608
    ds_read_b64_tr_b16 v[84:85], v57 offset:0
    ds_read_b64_tr_b16 v[86:87], v57 offset:4608
    ds_read_b64_tr_b16 v[88:89], v58 offset:0
    ds_read_b64_tr_b16 v[90:91], v58 offset:4608
    ds_read_b64_tr_b16 v[92:93], v59 offset:0
    ds_read_b64_tr_b16 v[94:95], v59 offset:4608
    ds_read_b64_tr_b16 v[96:97], v56 offset:36864
    ds_read_b64_tr_b16 v[98:99], v56 offset:41472
    ds_read_b64_tr_b16 v[100:101], v57 offset:36864
    ds_read_b64_tr_b16 v[102:103], v57 offset:41472
    ds_read_b64_tr_b16 v[104:105], v58 offset:36864
    ds_read_b64_tr_b16 v[106:107], v58 offset:41472
    ds_read_b64_tr_b16 v[108:109], v59 offset:36864
    ds_read_b64_tr_b16 v[110:111], v59 offset:41472
    s_waitcnt lgkmcnt(8)
    v_mfma_f32_16x16x32_bf16 v[36:39], v[20:23], v[80:83], 0
    v_mfma_f32_16x16x32_bf16 v[40:43], v[20:23], v[84:87], 0
    v_mfma_f32_16x16x32_bf16 v[44:47], v[20:23], v[88:91], 0
    v_mfma_f32_16x16x32_bf16 v[48:51], v[20:23], v[92:95], 0
    s_branch L_g32_11_in
L_g32_11:
    buffer_load_dwordx4 v[16:19], v1, s[12:15], s46 offen sc1
    s_sub_u32 s42, s42, 1
    s_cbranch_scc1 L_END
    s_andn2_b32 s46, s46, 5242880
    s_and_b32 s7, s42, 31
    s_cselect_b32 s7, 0, 5242880
    s_add_u32 s46, s46, s7
L_g32_11_in:
    s_waitcnt vmcnt(0)
L_g32_11_chk:
    v_xor_b32 v16, s40, v16
    v_xor_b32 v17, s40, v17
    v_xor_b32 v18, s40, v18
    v_xor_b32 v19, s40, v19
    v_or3_b32 v8, v16, v17, v18
    v_or_b32 v8, v8, v19
    v_and_b32 v8, 0xfff, v8
    v_cmp_ne_u32 vcc, 0, v8
    v_permlane32_swap_b32 v16, v17
    v_permlane32_swap_b32 v18, v19
    s_cbranch_vccnz L_g32_11
    v_add_f32 v16, v16, v17
    v_add_f32 v18, v18, v19
    s_nop 1
    v_permlane16_swap_b32 v16, v18
    v_add_f32 v16, v16, v18
    v_cvt_pk_bf16_f32 v16, v16, v16
    ds_write_b16 v60, v16 offset:128
L_Y_c:
    s_waitcnt lgkmcnt(0)
    s_barrier
    ds_read_b128 v[24:27], v61 offset:128
    s_waitcnt lgkmcnt(0)
    v_mfma_f32_16x16x32_bf16 v[36:39], v[24:27], v[96:99], v[36:39]
    v_mfma_f32_16x16x32_bf16 v[40:43], v[24:27], v[100:103], v[40:43]
    v_mfma_f32_16x16x32_bf16 v[44:47], v[24:27], v[104:107], v[44:47]
    v_mfma_f32_16x16x32_bf16 v[48:51], v[24:27], v[108:111], v[48:51]
    s_nop 5
    v_cndmask_b32 v36, v36, v40, s[98:99]
    v_cndmask_b32 v37, v37, v41, s[98:99]
    v_cndmask_b32 v44, v44, v48, s[98:99]
    v_cndmask_b32 v45, v45, v49, s[98:99]
    v_cndmask_b32 v36, v36, v44, s[48:49]
    v_cndmask_b32 v37, v37, v45, s[48:49]
    v_add_u32 v36, 0x8000, v36
    v_add_u32 v37, 0x8000, v37
    v_cvt_pk_bf16_f32 v36, v36, v37
    v_bfi_b32 v36, s57, v36, v6
    buffer_store_dword v36, v62, s[12:15], s47 offen sc1
L_END:
L_EXIT:
    s_endpgm
.fill 1200, 4, 0xbf810000
.section .rodata,"a"
.p2align 6
.amdhsa_kernel parallel_sum__compressed_kv_cla__dense_activation_squared_relu__decode_kernel
  .amdhsa_next_free_vgpr 168
  .amdhsa_next_free_sgpr 102
  .amdhsa_accum_offset 168
  .amdhsa_group_segment_fixed_size 0
  .amdhsa_kernarg_size 112
  .amdhsa_user_sgpr_count 2
  .amdhsa_user_sgpr_kernarg_segment_ptr 1
  .amdhsa_system_sgpr_workgroup_id_x 1
.end_amdhsa_kernel
```
